```python
import torch

def _softmax(x, axis=-1):
    return torch.softmax(x, dim=axis)
def _gelu(x):
    return torch.nn.functional.gelu(x, approximate="tanh")
def _silu(x):
    return torch.nn.functional.silu(x)
def _sigmoid(x):
    return torch.sigmoid(x)
def _layernorm(x, axis=-1, eps=1e-5):
    m = x.mean(dim=axis, keepdim=True)
    v = x.var(dim=axis, keepdim=True, unbiased=False)
    return (x - m) / torch.sqrt(v + eps)
def _scatter_add(tgt, idx, src, axis=0):
    return tgt.clone().index_add_(axis, idx, src)
def _segment_sum(src, seg, n):
    out = torch.zeros((n,) + src.shape[1:], dtype=src.dtype)
    return out.index_add_(0, seg, src)
def _pad(x, pw):
    flat = tuple(v for pair in reversed(pw) for v in pair)
    return torch.nn.functional.pad(x, flat)

kernel_name = 'gated_mix__sliding_local_dilated__mha_block__prompt'

def setup_inputs():

    _w = (lambda a: (lambda t: t.to(torch.bfloat16) if t.is_floating_point() else t)(torch.as_tensor(a)))
    def _A_setup():
        B, S, D = 1, 2048, 448
        return {
            "x": _w((lambda *s: torch.randn(*s, dtype=torch.bfloat16) * 0.05)(B, S, D)),
            "wqkv": _w((lambda *s: torch.randn(*s, dtype=torch.bfloat16) * 1.6)(D, 3 * D)),
            "wo": _w((lambda *s: torch.randn(*s, dtype=torch.bfloat16) * 0.05)(D, D)),
        }
    _A_in = _A_setup()

    def _B_setup():
        B, S, D, H = 1, 2048, 448, 16
        return {
            "x": _w((lambda *s: torch.randn(*s, dtype=torch.bfloat16) * 0.05)(B, S, D)),
            "wqkv": _w((lambda *s: torch.randn(*s, dtype=torch.bfloat16) * 1.6)(D, 3 * D)),
            "wo": _w((lambda *s: torch.randn(*s, dtype=torch.bfloat16) * 0.1)(D, D)),
        }
    _B_in = _B_setup()

    return {
        "A_x": _A_in["x"],
        "A_wqkv": _A_in["wqkv"],
        "A_wo": _A_in["wo"],
        "B_x": _B_in["x"],
        "B_wqkv": _B_in["wqkv"],
        "B_wo": _B_in["wo"],
        "gate_w": _w((lambda *s: torch.randn(*s, dtype=torch.bfloat16) * 0.05)(448) * 16.0),
    }

def reference(A_x, A_wqkv, A_wo, B_x, B_wqkv, B_wo, gate_w):
    def _A_ref(x, wqkv, wo):
        B, S, D = x.shape
        H = 16; Dh = D // H
        W, dil = 8, 2
        qkv = (lambda x, *d: x.permute(*d))((x @ wqkv).reshape(B, S, 3, H, Dh), 2, 0, 3, 1, 4)
        q, k, v = qkv[0], qkv[1], qkv[2]
        scale = Dh ** -0.5
        pos = torch.arange(S)
        off = torch.arange(W) * dil
        idx = pos[:, None] - off[None, :]
        mask = idx >= 0
        idx_c = torch.where(mask, idx, 0).reshape(-1)
        kg = k[:, :, idx_c, :].reshape(B, H, S, W, Dh)
        vg = v[:, :, idx_c, :].reshape(B, H, S, W, Dh)
        logits = torch.einsum("bhsd,bhswd->bhsw", q, kg) * scale
        logits = torch.where(mask[None, None, :, :], logits, -1e9)
        attn = _softmax(logits, axis=-1)
        o = torch.einsum("bhsw,bhswd->bhsd", attn, vg)
        return (lambda x, *d: x.permute(*d))(o, 0, 2, 1, 3).reshape(B, S, D) @ wo

    def _B_ref(x, wqkv, wo):
        B, S, D = x.shape
        H = 16
        Dh = D // H
        qkv = (lambda x, *d: x.permute(*d))((x @ wqkv).reshape(B, S, 3, H, Dh), 2, 0, 3, 1, 4)
        q, k, v = qkv[0], qkv[1], qkv[2]
        scores = torch.einsum("bhqd,bhkd->bhqk", q, k) * (Dh ** -0.5)
        p = _softmax(scores, axis=-1)
        o = torch.einsum("bhqk,bhkd->bhqd", p, v)
        return (lambda x, *d: x.permute(*d))(o, 0, 2, 1, 3).reshape(B, S, D) @ wo

    x = A_x
    g = _sigmoid((x * gate_w).sum(-1, keepdims=True))
    a = _A_ref(x, A_wqkv, A_wo)
    b = _B_ref(x, B_wqkv, B_wo)
    return g * a + (1 - g) * b
```

```asm
; @launch kernel=qkv_kernel grid=(256,1,1) block=(512,1,1) lds=136192
; @launch kernel=attn_kernel grid=(256,1,1) block=(512,1,1) lds=149760
; @launch kernel=proj_kernel grid=(224,1,1) block=(256,1,1) lds=123904
.amdgcn_target "amdgcn-amd-amdhsa--gfx950"
.text
.globl qkv_kernel
.p2align 8
.type qkv_kernel,@function
qkv_kernel:
    s_cmp_ge_u32 s2, 256
    s_cbranch_scc1 Lk1_end
    s_load_dwordx2 s[4:5], s[0:1], 0
    s_load_dwordx2 s[6:7], s[0:1], 8
    s_load_dwordx2 s[8:9], s[0:1], 32
    s_load_dwordx2 s[10:11], s[0:1], 48
    s_load_dwordx2 s[12:13], s[0:1], 72
    s_and_b32 s32, s2, 7
    s_lshr_b32 s33, s2, 3
    s_and_b32 s34, s32, 1
    s_lshl_b32 s34, s34, 3
    s_and_b32 s36, s33, 7
    s_add_u32 s34, s34, s36
    s_lshr_b32 s35, s32, 1
    s_lshl_b32 s35, s35, 2
    s_lshr_b32 s36, s33, 3
    s_add_u32 s35, s35, s36
    s_lshr_b32 s36, s35, 3
    s_and_b32 s37, s35, 7
    v_lshrrev_b32 v1, 6, v0
    v_and_b32 v2, 63, v0
    v_readfirstlane_b32 s38, v1
    s_waitcnt lgkmcnt(0)
    s_mov_b32 s16, s4
    s_and_b32 s17, s5, 0xffff
    s_mov_b32 s18, 1835008
    s_mov_b32 s19, 0x00020000
    s_cmp_eq_u32 s36, 0
    s_cselect_b32 s6, s6, s8
    s_cselect_b32 s7, s7, s9
    s_mov_b32 s20, s6
    s_and_b32 s21, s7, 0xffff
    s_mov_b32 s22, 1204224
    s_mov_b32 s23, 0x00020000
    s_mov_b32 s24, s12
    s_and_b32 s25, s13, 0xffff
    s_mov_b32 s26, 16785408
    s_mov_b32 s27, 0x00020000
    s_mov_b32 s28, s10
    s_and_b32 s29, s11, 0xffff
    s_mov_b32 s30, 896
    s_mov_b32 s31, 0x00020000
    s_and_b32 s56, s38, 3
    s_lshr_b32 s57, s38, 2
    s_lshl_b32 s39, s34, 2
    s_add_u32 s39, s39, s56
    s_mul_i32 s58, s37, 6
    s_mul_i32 s59, s57, 3
    s_add_u32 s58, s58, s59
    s_lshl_b32 s40, s34, 7
    s_lshl_b32 s43, s38, 4
    s_add_u32 s40, s40, s43
    s_mul_i32 s40, s40, 896
    s_lshl_b32 s41, s38, 11
    s_mul_i32 s42, s37, 336
    s_lshl_b32 s45, s38, 10
    s_add_u32 s45, s45, 49152
    v_lshrrev_b32 v3, 3, v2
    v_mul_u32_u24 v4, 896, v3
    v_and_b32 v3, 7, v2
    v_lshrrev_b32 v6, 4, v2
    v_xor_b32 v3, v3, v6
    v_lshlrev_b32 v6, 4, v3
    v_xor_b32 v7, 64, v6
    v_add_u32 v5, v4, v7
    v_add_u32 v4, v4, v6
    s_lshl_b32 s43, s38, 6
    v_add_u32 v3, s43, v2
    s_mov_b32 s44, 0x92492493
    v_add_u32 v6, 0, v3
    v_lshrrev_b32 v7, 2, v6
    v_mul_hi_u32 v7, v7, s44
    v_lshrrev_b32 v7, 2, v7
    v_mul_u32_u24 v8, 28, v7
    v_sub_u32 v8, v6, v8
    v_mul_u32_u24 v7, 2688, v7
    v_lshl_add_u32 v7, v8, 4, v7
    v_cmp_gt_u32 vcc, 22, v8
    v_mov_b32 v9, 0x7ff00000
    s_nop 0
    v_cndmask_b32 v136, v9, v7, vcc
    v_add_u32 v6, 512, v3
    v_lshrrev_b32 v7, 2, v6
    v_mul_hi_u32 v7, v7, s44
    v_lshrrev_b32 v7, 2, v7
    v_mul_u32_u24 v8, 28, v7
    v_sub_u32 v8, v6, v8
    v_mul_u32_u24 v7, 2688, v7
    v_lshl_add_u32 v7, v8, 4, v7
    v_cmp_gt_u32 vcc, 22, v8
    v_mov_b32 v9, 0x7ff00000
    s_nop 0
    v_cndmask_b32 v137, v9, v7, vcc
    v_add_u32 v6, 1024, v3
    v_lshrrev_b32 v7, 2, v6
    v_mul_hi_u32 v7, v7, s44
    v_lshrrev_b32 v7, 2, v7
    v_mul_u32_u24 v8, 28, v7
    v_sub_u32 v8, v6, v8
    v_mul_u32_u24 v7, 2688, v7
    v_lshl_add_u32 v7, v8, 4, v7
    v_cmp_gt_u32 vcc, 22, v8
    v_mov_b32 v9, 0x7ff00000
    s_nop 0
    v_cndmask_b32 v138, v9, v7, vcc
    v_add_u32 v6, 1536, v3
    v_lshrrev_b32 v7, 2, v6
    v_mul_hi_u32 v7, v7, s44
    v_lshrrev_b32 v7, 2, v7
    v_mul_u32_u24 v8, 28, v7
    v_sub_u32 v8, v6, v8
    v_mul_u32_u24 v7, 2688, v7
    v_lshl_add_u32 v7, v8, 4, v7
    v_cmp_gt_u32 vcc, 22, v8
    v_mov_b32 v9, 0x7ff00000
    s_nop 0
    v_cndmask_b32 v139, v9, v7, vcc
    s_add_u32 s43, s35, s57
    s_cmp_eq_u32 s43, 0
    s_cselect_b32 s53, 1, 0
    s_mov_b32 s54, 0x10000000
    s_mov_b32 s55, 0x10000000
    v_lshrrev_b32 v3, 5, v2
    v_lshlrev_b32 v13, 4, v3
    v_add_u32 v13, 135168, v13
    v_lshlrev_b32 v12, 4, v2
    s_cmp_eq_u32 s53, 1
    s_cbranch_scc0 Lk1_nog0
    s_mov_b32 m0, 135168
    s_nop 0
    buffer_load_dwordx4 v12, s[28:31], 0 offen lds
Lk1_nog0:
    s_add_u32 m0, s41, 0
    s_add_u32 s43, s40, 0
    buffer_load_dwordx4 v4, s[16:19], s43 offen lds
    s_add_u32 m0, s41, 1024
    s_add_u32 s43, s40, 7168
    buffer_load_dwordx4 v5, s[16:19], s43 offen lds
    s_add_u32 s43, s42, 0
    s_add_u32 m0, s45, 0
    s_nop 0
    buffer_load_dwordx4 v136, s[20:23], s43 offen lds
    s_add_u32 s43, s42, 0
    s_add_u32 m0, s45, 8192
    s_nop 0
    buffer_load_dwordx4 v137, s[20:23], s43 offen lds
    s_add_u32 m0, s45, 16384
    s_nop 0
    buffer_load_dwordx4 v138, s[20:23], s43 offen lds
    s_cmp_lt_u32 s38, 4
    s_cbranch_scc0 Lk1_d1
    s_add_u32 s43, s42, 0
    s_add_u32 m0, s45, 24576
    s_nop 0
    buffer_load_dwordx4 v139, s[20:23], s43 offen lds
Lk1_d1:
    s_add_u32 m0, s41, 16384
    s_add_u32 s43, s40, 128
    buffer_load_dwordx4 v4, s[16:19], s43 offen lds
    s_add_u32 m0, s41, 17408
    s_add_u32 s43, s40, 7296
    buffer_load_dwordx4 v5, s[16:19], s43 offen lds
    s_add_u32 s43, s42, 172032
    s_add_u32 m0, s45, 28672
    s_nop 0
    buffer_load_dwordx4 v136, s[20:23], s43 offen lds
    s_add_u32 s43, s42, 172032
    s_add_u32 m0, s45, 36864
    s_nop 0
    buffer_load_dwordx4 v137, s[20:23], s43 offen lds
    s_add_u32 m0, s45, 45056
    s_nop 0
    buffer_load_dwordx4 v138, s[20:23], s43 offen lds
    s_cmp_lt_u32 s38, 4
    s_cbranch_scc0 Lk1_d2
    s_add_u32 s43, s42, 172032
    s_add_u32 m0, s45, 53248
    s_nop 0
    buffer_load_dwordx4 v139, s[20:23], s43 offen lds
Lk1_d2:
    v_and_b32 v3, 31, v2
    v_lshrrev_b32 v8, 1, v3
    v_and_b32 v8, 7, v8
    v_lshrrev_b32 v9, 5, v2
    v_xor_b32 v8, v8, v9
    v_lshlrev_b32 v8, 4, v8
    v_lshlrev_b32 v3, 7, v3
    s_lshl_b32 s43, s56, 12
    v_add3_u32 v120, v3, v8, s43
    v_xor_b32 v121, 32, v120
    v_xor_b32 v122, 64, v120
    v_xor_b32 v123, 96, v120
    v_lshrrev_b32 v3, 5, v2
    v_lshlrev_b32 v3, 3, v3
    v_and_b32 v8, 15, v2
    v_lshrrev_b32 v8, 2, v8
    v_add_u32 v3, v3, v8
    v_mul_u32_u24 v11, 448, v3
    v_lshrrev_b32 v3, 4, v2
    v_and_b32 v3, 1, v3
    v_lshlrev_b32 v3, 5, v3
    v_add_u32 v11, v11, v3
    v_and_b32 v3, 3, v2
    v_lshlrev_b32 v3, 3, v3
    v_add_u32 v11, v11, v3
    s_mul_i32 s43, s57, 168
    s_add_u32 s43, s43, 49152
    v_add_u32 v124, s43, v11
    v_add_u32 v125, 28672, v124
    v_add_u32 v126, 57344, v124
    s_mov_b32 s48, 0xffffffff
    s_mov_b32 s49, 0
    s_mov_b32 s50, 0x0fffffff
    s_mov_b32 s51, 0x0fffffff
    v_and_b32 v3, 31, v2
    v_mov_b32 v9, 0x3f803f80
    v_cmp_eq_u32 vcc, 28, v3
    s_nop 1
    v_cndmask_b32 v9, 0, v9, vcc
    s_cmp_ge_u32 s58, 32
    s_cbranch_scc1 Lk1_var2
    s_cmp_eq_u32 s58, 30
    s_cbranch_scc1 Lk1_var1
    s_waitcnt vmcnt(5)
    s_barrier
    s_cmp_eq_u32 s53, 1
    s_cbranch_scc0 Lk1_gr0
    ds_read_b128 v[128:131], v13 offset:0
Lk1_gr0:
    ds_read_b128 v[88:91], v120 offset:0
    ds_read_b64_tr_b16 v[64:65], v124 offset:0
    ds_read_b64_tr_b16 v[66:67], v124 offset:1792
    ds_read_b64_tr_b16 v[68:69], v124 offset:56
    ds_read_b64_tr_b16 v[70:71], v124 offset:1848
    ds_read_b64_tr_b16 v[72:73], v124 offset:112
    ds_read_b64_tr_b16 v[74:75], v124 offset:1904
    s_cmp_eq_u32 s53, 1
    s_cbranch_scc0 Lk1_gr1
    ds_read_b128 v[132:135], v13 offset:32
Lk1_gr1:
    ds_read_b128 v[92:95], v121 offset:0
    ds_read_b64_tr_b16 v[76:77], v124 offset:7168
    ds_read_b64_tr_b16 v[78:79], v124 offset:8960
    ds_read_b64_tr_b16 v[80:81], v124 offset:7224
    ds_read_b64_tr_b16 v[82:83], v124 offset:9016
    ds_read_b64_tr_b16 v[84:85], v124 offset:7280
    ds_read_b64_tr_b16 v[86:87], v124 offset:9072
    s_waitcnt lgkmcnt(7)
    s_cmp_eq_u32 s53, 1
    s_cbranch_scc0 Lk1_ng0
    v_cndmask_b32 v64, v64, v128, s[54:55]
    v_cndmask_b32 v65, v65, v129, s[54:55]
    v_cndmask_b32 v66, v66, v130, s[54:55]
    v_cndmask_b32 v67, v67, v131, s[54:55]
    s_nop 1
Lk1_ng0:
    v_mfma_f32_32x32x16_bf16 v[16:31], v[64:67], v[88:91], 0
    v_mfma_f32_32x32x16_bf16 v[32:47], v[68:71], v[88:91], 0
    v_mfma_f32_32x32x16_bf16 v[48:63], v[72:75], v[88:91], 0
    s_add_u32 m0, s41, 32768
    s_add_u32 s43, s40, 256
    buffer_load_dwordx4 v4, s[16:19], s43 offen lds
    s_add_u32 m0, s41, 33792
    s_add_u32 s43, s40, 7424
    buffer_load_dwordx4 v5, s[16:19], s43 offen lds
    s_cmp_eq_u32 s53, 1
    s_cbranch_scc0 Lk1_gr2
    ds_read_b128 v[128:131], v13 offset:64
Lk1_gr2:
    ds_read_b128 v[88:91], v122 offset:0
    ds_read_b64_tr_b16 v[64:65], v124 offset:14336
    ds_read_b64_tr_b16 v[66:67], v124 offset:16128
    ds_read_b64_tr_b16 v[68:69], v124 offset:14392
    ds_read_b64_tr_b16 v[70:71], v124 offset:16184
    ds_read_b64_tr_b16 v[72:73], v124 offset:14448
    ds_read_b64_tr_b16 v[74:75], v124 offset:16240
    s_waitcnt lgkmcnt(7)
    s_cmp_eq_u32 s53, 1
    s_cbranch_scc0 Lk1_ng1
    v_cndmask_b32 v76, v76, v132, s[54:55]
    v_cndmask_b32 v77, v77, v133, s[54:55]
    v_cndmask_b32 v78, v78, v134, s[54:55]
    v_cndmask_b32 v79, v79, v135, s[54:55]
    s_nop 1
Lk1_ng1:
    v_mfma_f32_32x32x16_bf16 v[16:31], v[76:79], v[92:95], v[16:31]
    v_mfma_f32_32x32x16_bf16 v[32:47], v[80:83], v[92:95], v[32:47]
    v_mfma_f32_32x32x16_bf16 v[48:63], v[84:87], v[92:95], v[48:63]
    s_add_u32 s43, s42, 344064
    s_add_u32 m0, s45, 57344
    s_nop 0
    buffer_load_dwordx4 v136, s[20:23], s43 offen lds
    s_cmp_eq_u32 s53, 1
    s_cbranch_scc0 Lk1_gr3
    ds_read_b128 v[132:135], v13 offset:96
Lk1_gr3:
    ds_read_b128 v[92:95], v123 offset:0
    ds_read_b64_tr_b16 v[76:77], v124 offset:21504
    ds_read_b64_tr_b16 v[78:79], v124 offset:23296
    ds_read_b64_tr_b16 v[80:81], v124 offset:21560
    ds_read_b64_tr_b16 v[82:83], v124 offset:23352
    ds_read_b64_tr_b16 v[84:85], v124 offset:21616
    ds_read_b64_tr_b16 v[86:87], v124 offset:23408
    s_waitcnt lgkmcnt(7)
    s_cmp_eq_u32 s53, 1
    s_cbranch_scc0 Lk1_ng2
    v_cndmask_b32 v64, v64, v128, s[54:55]
    v_cndmask_b32 v65, v65, v129, s[54:55]
    v_cndmask_b32 v66, v66, v130, s[54:55]
    v_cndmask_b32 v67, v67, v131, s[54:55]
    s_nop 1
Lk1_ng2:
    v_mfma_f32_32x32x16_bf16 v[16:31], v[64:67], v[88:91], v[16:31]
    v_mfma_f32_32x32x16_bf16 v[32:47], v[68:71], v[88:91], v[32:47]
    v_mfma_f32_32x32x16_bf16 v[48:63], v[72:75], v[88:91], v[48:63]
    s_add_u32 s43, s42, 344064
    s_add_u32 m0, s45, 65536
    s_nop 0
    buffer_load_dwordx4 v137, s[20:23], s43 offen lds
    s_add_u32 m0, s45, 73728
    s_nop 0
    buffer_load_dwordx4 v138, s[20:23], s43 offen lds
    s_waitcnt lgkmcnt(0)
    s_waitcnt vmcnt(5)
    s_barrier
    s_cmp_eq_u32 s53, 1
    s_cbranch_scc0 Lk1_gr4
    ds_read_b128 v[128:131], v13 offset:128
Lk1_gr4:
    ds_read_b128 v[88:91], v120 offset:16384
    ds_read_b64_tr_b16 v[64:65], v125 offset:0
    ds_read_b64_tr_b16 v[66:67], v125 offset:1792
    ds_read_b64_tr_b16 v[68:69], v125 offset:56
    ds_read_b64_tr_b16 v[70:71], v125 offset:1848
    ds_read_b64_tr_b16 v[72:73], v125 offset:112
    ds_read_b64_tr_b16 v[74:75], v125 offset:1904
    s_cmp_eq_u32 s53, 1
    s_cbranch_scc0 Lk1_ng3
    v_cndmask_b32 v76, v76, v132, s[54:55]
    v_cndmask_b32 v77, v77, v133, s[54:55]
    v_cndmask_b32 v78, v78, v134, s[54:55]
    v_cndmask_b32 v79, v79, v135, s[54:55]
    s_nop 1
Lk1_ng3:
    v_mfma_f32_32x32x16_bf16 v[16:31], v[76:79], v[92:95], v[16:31]
    v_mfma_f32_32x32x16_bf16 v[32:47], v[80:83], v[92:95], v[32:47]
    v_mfma_f32_32x32x16_bf16 v[48:63], v[84:87], v[92:95], v[48:63]
    s_cmp_lt_u32 s38, 4
    s_cbranch_scc0 Lk1_d3
    s_add_u32 s43, s42, 344064
    s_add_u32 m0, s45, 81920
    s_nop 0
    buffer_load_dwordx4 v139, s[20:23], s43 offen lds
Lk1_d3:
    s_cmp_eq_u32 s53, 1
    s_cbranch_scc0 Lk1_gr5
    ds_read_b128 v[132:135], v13 offset:160
Lk1_gr5:
    ds_read_b128 v[92:95], v121 offset:16384
    ds_read_b64_tr_b16 v[76:77], v125 offset:7168
    ds_read_b64_tr_b16 v[78:79], v125 offset:8960
    ds_read_b64_tr_b16 v[80:81], v125 offset:7224
    ds_read_b64_tr_b16 v[82:83], v125 offset:9016
    ds_read_b64_tr_b16 v[84:85], v125 offset:7280
    ds_read_b64_tr_b16 v[86:87], v125 offset:9072
    s_waitcnt lgkmcnt(7)
    s_cmp_eq_u32 s53, 1
    s_cbranch_scc0 Lk1_ng4
    v_cndmask_b32 v64, v64, v128, s[54:55]
    v_cndmask_b32 v65, v65, v129, s[54:55]
    v_cndmask_b32 v66, v66, v130, s[54:55]
    v_cndmask_b32 v67, v67, v131, s[54:55]
    s_nop 1
Lk1_ng4:
    v_mfma_f32_32x32x16_bf16 v[16:31], v[64:67], v[88:91], v[16:31]
    v_mfma_f32_32x32x16_bf16 v[32:47], v[68:71], v[88:91], v[32:47]
    v_mfma_f32_32x32x16_bf16 v[48:63], v[72:75], v[88:91], v[48:63]
    s_add_u32 m0, s41, 0
    s_add_u32 s43, s40, 384
    buffer_load_dwordx4 v4, s[16:19], s43 offen lds
    s_add_u32 m0, s41, 1024
    s_add_u32 s43, s40, 7552
    buffer_load_dwordx4 v5, s[16:19], s43 offen lds
    s_cmp_eq_u32 s53, 1
    s_cbranch_scc0 Lk1_gr6
    ds_read_b128 v[128:131], v13 offset:192
Lk1_gr6:
    ds_read_b128 v[88:91], v122 offset:16384
    ds_read_b64_tr_b16 v[64:65], v125 offset:14336
    ds_read_b64_tr_b16 v[66:67], v125 offset:16128
    ds_read_b64_tr_b16 v[68:69], v125 offset:14392
    ds_read_b64_tr_b16 v[70:71], v125 offset:16184
    ds_read_b64_tr_b16 v[72:73], v125 offset:14448
    ds_read_b64_tr_b16 v[74:75], v125 offset:16240
    s_waitcnt lgkmcnt(7)
    s_cmp_eq_u32 s53, 1
    s_cbranch_scc0 Lk1_ng5
    v_cndmask_b32 v76, v76, v132, s[54:55]
    v_cndmask_b32 v77, v77, v133, s[54:55]
    v_cndmask_b32 v78, v78, v134, s[54:55]
    v_cndmask_b32 v79, v79, v135, s[54:55]
    s_nop 1
Lk1_ng5:
    v_mfma_f32_32x32x16_bf16 v[16:31], v[76:79], v[92:95], v[16:31]
    v_mfma_f32_32x32x16_bf16 v[32:47], v[80:83], v[92:95], v[32:47]
    v_mfma_f32_32x32x16_bf16 v[48:63], v[84:87], v[92:95], v[48:63]
    s_add_u32 s43, s42, 516096
    s_add_u32 m0, s45, 0
    s_nop 0
    buffer_load_dwordx4 v136, s[20:23], s43 offen lds
    s_cmp_eq_u32 s53, 1
    s_cbranch_scc0 Lk1_gr7
    ds_read_b128 v[132:135], v13 offset:224
Lk1_gr7:
    ds_read_b128 v[92:95], v123 offset:16384
    ds_read_b64_tr_b16 v[76:77], v125 offset:21504
    ds_read_b64_tr_b16 v[78:79], v125 offset:23296
    ds_read_b64_tr_b16 v[80:81], v125 offset:21560
    ds_read_b64_tr_b16 v[82:83], v125 offset:23352
    ds_read_b64_tr_b16 v[84:85], v125 offset:21616
    ds_read_b64_tr_b16 v[86:87], v125 offset:23408
    s_waitcnt lgkmcnt(7)
    s_cmp_eq_u32 s53, 1
    s_cbranch_scc0 Lk1_ng6
    v_cndmask_b32 v64, v64, v128, s[54:55]
    v_cndmask_b32 v65, v65, v129, s[54:55]
    v_cndmask_b32 v66, v66, v130, s[54:55]
    v_cndmask_b32 v67, v67, v131, s[54:55]
    s_nop 1
Lk1_ng6:
    v_mfma_f32_32x32x16_bf16 v[16:31], v[64:67], v[88:91], v[16:31]
    v_mfma_f32_32x32x16_bf16 v[32:47], v[68:71], v[88:91], v[32:47]
    v_mfma_f32_32x32x16_bf16 v[48:63], v[72:75], v[88:91], v[48:63]
    s_add_u32 s43, s42, 516096
    s_add_u32 m0, s45, 8192
    s_nop 0
    buffer_load_dwordx4 v137, s[20:23], s43 offen lds
    s_add_u32 m0, s45, 16384
    s_nop 0
    buffer_load_dwordx4 v138, s[20:23], s43 offen lds
    s_waitcnt lgkmcnt(0)
    s_waitcnt vmcnt(5)
    s_barrier
    s_cmp_eq_u32 s53, 1
    s_cbranch_scc0 Lk1_gr8
    ds_read_b128 v[128:131], v13 offset:256
Lk1_gr8:
    ds_read_b128 v[88:91], v120 offset:32768
    ds_read_b64_tr_b16 v[64:65], v126 offset:0
    ds_read_b64_tr_b16 v[66:67], v126 offset:1792
    ds_read_b64_tr_b16 v[68:69], v126 offset:56
    ds_read_b64_tr_b16 v[70:71], v126 offset:1848
    ds_read_b64_tr_b16 v[72:73], v126 offset:112
    ds_read_b64_tr_b16 v[74:75], v126 offset:1904
    s_cmp_eq_u32 s53, 1
    s_cbranch_scc0 Lk1_ng7
    v_cndmask_b32 v76, v76, v132, s[54:55]
    v_cndmask_b32 v77, v77, v133, s[54:55]
    v_cndmask_b32 v78, v78, v134, s[54:55]
    v_cndmask_b32 v79, v79, v135, s[54:55]
    s_nop 1
Lk1_ng7:
    v_mfma_f32_32x32x16_bf16 v[16:31], v[76:79], v[92:95], v[16:31]
    v_mfma_f32_32x32x16_bf16 v[32:47], v[80:83], v[92:95], v[32:47]
    v_mfma_f32_32x32x16_bf16 v[48:63], v[84:87], v[92:95], v[48:63]
    s_cmp_lt_u32 s38, 4
    s_cbranch_scc0 Lk1_d4
    s_add_u32 s43, s42, 516096
    s_add_u32 m0, s45, 24576
    s_nop 0
    buffer_load_dwordx4 v139, s[20:23], s43 offen lds
Lk1_d4:
    s_cmp_eq_u32 s53, 1
    s_cbranch_scc0 Lk1_gr9
    ds_read_b128 v[132:135], v13 offset:288
Lk1_gr9:
    ds_read_b128 v[92:95], v121 offset:32768
    ds_read_b64_tr_b16 v[76:77], v126 offset:7168
    ds_read_b64_tr_b16 v[78:79], v126 offset:8960
    ds_read_b64_tr_b16 v[80:81], v126 offset:7224
    ds_read_b64_tr_b16 v[82:83], v126 offset:9016
    ds_read_b64_tr_b16 v[84:85], v126 offset:7280
    ds_read_b64_tr_b16 v[86:87], v126 offset:9072
    s_waitcnt lgkmcnt(7)
    s_cmp_eq_u32 s53, 1
    s_cbranch_scc0 Lk1_ng8
    v_cndmask_b32 v64, v64, v128, s[54:55]
    v_cndmask_b32 v65, v65, v129, s[54:55]
    v_cndmask_b32 v66, v66, v130, s[54:55]
    v_cndmask_b32 v67, v67, v131, s[54:55]
    s_nop 1
Lk1_ng8:
    v_mfma_f32_32x32x16_bf16 v[16:31], v[64:67], v[88:91], v[16:31]
    v_mfma_f32_32x32x16_bf16 v[32:47], v[68:71], v[88:91], v[32:47]
    v_mfma_f32_32x32x16_bf16 v[48:63], v[72:75], v[88:91], v[48:63]
    s_add_u32 m0, s41, 16384
    s_add_u32 s43, s40, 512
    buffer_load_dwordx4 v4, s[16:19], s43 offen lds
    s_add_u32 m0, s41, 17408
    s_add_u32 s43, s40, 7680
    buffer_load_dwordx4 v5, s[16:19], s43 offen lds
    s_cmp_eq_u32 s53, 1
    s_cbranch_scc0 Lk1_gr10
    ds_read_b128 v[128:131], v13 offset:320
Lk1_gr10:
    ds_read_b128 v[88:91], v122 offset:32768
    ds_read_b64_tr_b16 v[64:65], v126 offset:14336
    ds_read_b64_tr_b16 v[66:67], v126 offset:16128
    ds_read_b64_tr_b16 v[68:69], v126 offset:14392
    ds_read_b64_tr_b16 v[70:71], v126 offset:16184
    ds_read_b64_tr_b16 v[72:73], v126 offset:14448
    ds_read_b64_tr_b16 v[74:75], v126 offset:16240
    s_waitcnt lgkmcnt(7)
    s_cmp_eq_u32 s53, 1
    s_cbranch_scc0 Lk1_ng9
    v_cndmask_b32 v76, v76, v132, s[54:55]
    v_cndmask_b32 v77, v77, v133, s[54:55]
    v_cndmask_b32 v78, v78, v134, s[54:55]
    v_cndmask_b32 v79, v79, v135, s[54:55]
    s_nop 1
Lk1_ng9:
    v_mfma_f32_32x32x16_bf16 v[16:31], v[76:79], v[92:95], v[16:31]
    v_mfma_f32_32x32x16_bf16 v[32:47], v[80:83], v[92:95], v[32:47]
    v_mfma_f32_32x32x16_bf16 v[48:63], v[84:87], v[92:95], v[48:63]
    s_add_u32 s43, s42, 688128
    s_add_u32 m0, s45, 28672
    s_nop 0
    buffer_load_dwordx4 v136, s[20:23], s43 offen lds
    s_cmp_eq_u32 s53, 1
    s_cbranch_scc0 Lk1_gr11
    ds_read_b128 v[132:135], v13 offset:352
Lk1_gr11:
    ds_read_b128 v[92:95], v123 offset:32768
    ds_read_b64_tr_b16 v[76:77], v126 offset:21504
    ds_read_b64_tr_b16 v[78:79], v126 offset:23296
    ds_read_b64_tr_b16 v[80:81], v126 offset:21560
    ds_read_b64_tr_b16 v[82:83], v126 offset:23352
    ds_read_b64_tr_b16 v[84:85], v126 offset:21616
    ds_read_b64_tr_b16 v[86:87], v126 offset:23408
    s_waitcnt lgkmcnt(7)
    s_cmp_eq_u32 s53, 1
    s_cbranch_scc0 Lk1_ng10
    v_cndmask_b32 v64, v64, v128, s[54:55]
    v_cndmask_b32 v65, v65, v129, s[54:55]
    v_cndmask_b32 v66, v66, v130, s[54:55]
    v_cndmask_b32 v67, v67, v131, s[54:55]
    s_nop 1
Lk1_ng10:
    v_mfma_f32_32x32x16_bf16 v[16:31], v[64:67], v[88:91], v[16:31]
    v_mfma_f32_32x32x16_bf16 v[32:47], v[68:71], v[88:91], v[32:47]
    v_mfma_f32_32x32x16_bf16 v[48:63], v[72:75], v[88:91], v[48:63]
    s_add_u32 s43, s42, 688128
    s_add_u32 m0, s45, 36864
    s_nop 0
    buffer_load_dwordx4 v137, s[20:23], s43 offen lds
    s_add_u32 m0, s45, 45056
    s_nop 0
    buffer_load_dwordx4 v138, s[20:23], s43 offen lds
    s_waitcnt lgkmcnt(0)
    s_waitcnt vmcnt(5)
    s_barrier
    s_cmp_eq_u32 s53, 1
    s_cbranch_scc0 Lk1_gr12
    ds_read_b128 v[128:131], v13 offset:384
Lk1_gr12:
    ds_read_b128 v[88:91], v120 offset:0
    ds_read_b64_tr_b16 v[64:65], v124 offset:0
    ds_read_b64_tr_b16 v[66:67], v124 offset:1792
    ds_read_b64_tr_b16 v[68:69], v124 offset:56
    ds_read_b64_tr_b16 v[70:71], v124 offset:1848
    ds_read_b64_tr_b16 v[72:73], v124 offset:112
    ds_read_b64_tr_b16 v[74:75], v124 offset:1904
    s_cmp_eq_u32 s53, 1
    s_cbranch_scc0 Lk1_ng11
    v_cndmask_b32 v76, v76, v132, s[54:55]
    v_cndmask_b32 v77, v77, v133, s[54:55]
    v_cndmask_b32 v78, v78, v134, s[54:55]
    v_cndmask_b32 v79, v79, v135, s[54:55]
    s_nop 1
Lk1_ng11:
    v_mfma_f32_32x32x16_bf16 v[16:31], v[76:79], v[92:95], v[16:31]
    v_mfma_f32_32x32x16_bf16 v[32:47], v[80:83], v[92:95], v[32:47]
    v_mfma_f32_32x32x16_bf16 v[48:63], v[84:87], v[92:95], v[48:63]
    s_cmp_lt_u32 s38, 4
    s_cbranch_scc0 Lk1_d5
    s_add_u32 s43, s42, 688128
    s_add_u32 m0, s45, 53248
    s_nop 0
    buffer_load_dwordx4 v139, s[20:23], s43 offen lds
Lk1_d5:
    s_cmp_eq_u32 s53, 1
    s_cbranch_scc0 Lk1_gr13
    ds_read_b128 v[132:135], v13 offset:416
Lk1_gr13:
    ds_read_b128 v[92:95], v121 offset:0
    ds_read_b64_tr_b16 v[76:77], v124 offset:7168
    ds_read_b64_tr_b16 v[78:79], v124 offset:8960
    ds_read_b64_tr_b16 v[80:81], v124 offset:7224
    ds_read_b64_tr_b16 v[82:83], v124 offset:9016
    ds_read_b64_tr_b16 v[84:85], v124 offset:7280
    ds_read_b64_tr_b16 v[86:87], v124 offset:9072
    s_waitcnt lgkmcnt(7)
    s_cmp_eq_u32 s53, 1
    s_cbranch_scc0 Lk1_ng12
    v_cndmask_b32 v64, v64, v128, s[54:55]
    v_cndmask_b32 v65, v65, v129, s[54:55]
    v_cndmask_b32 v66, v66, v130, s[54:55]
    v_cndmask_b32 v67, v67, v131, s[54:55]
    s_nop 1
Lk1_ng12:
    v_mfma_f32_32x32x16_bf16 v[16:31], v[64:67], v[88:91], v[16:31]
    v_mfma_f32_32x32x16_bf16 v[32:47], v[68:71], v[88:91], v[32:47]
    v_mfma_f32_32x32x16_bf16 v[48:63], v[72:75], v[88:91], v[48:63]
    s_add_u32 m0, s41, 32768
    s_add_u32 s43, s40, 640
    buffer_load_dwordx4 v4, s[16:19], s43 offen lds
    s_add_u32 m0, s41, 33792
    s_add_u32 s43, s40, 7808
    buffer_load_dwordx4 v5, s[16:19], s43 offen lds
    s_cmp_eq_u32 s53, 1
    s_cbranch_scc0 Lk1_gr14
    ds_read_b128 v[128:131], v13 offset:448
Lk1_gr14:
    ds_read_b128 v[88:91], v122 offset:0
    ds_read_b64_tr_b16 v[64:65], v124 offset:14336
    ds_read_b64_tr_b16 v[66:67], v124 offset:16128
    ds_read_b64_tr_b16 v[68:69], v124 offset:14392
    ds_read_b64_tr_b16 v[70:71], v124 offset:16184
    ds_read_b64_tr_b16 v[72:73], v124 offset:14448
    ds_read_b64_tr_b16 v[74:75], v124 offset:16240
    s_waitcnt lgkmcnt(7)
    s_cmp_eq_u32 s53, 1
    s_cbranch_scc0 Lk1_ng13
    v_cndmask_b32 v76, v76, v132, s[54:55]
    v_cndmask_b32 v77, v77, v133, s[54:55]
    v_cndmask_b32 v78, v78, v134, s[54:55]
    v_cndmask_b32 v79, v79, v135, s[54:55]
    s_nop 1
Lk1_ng13:
    v_mfma_f32_32x32x16_bf16 v[16:31], v[76:79], v[92:95], v[16:31]
    v_mfma_f32_32x32x16_bf16 v[32:47], v[80:83], v[92:95], v[32:47]
    v_mfma_f32_32x32x16_bf16 v[48:63], v[84:87], v[92:95], v[48:63]
    s_add_u32 s43, s42, 860160
    s_add_u32 m0, s45, 57344
    s_nop 0
    buffer_load_dwordx4 v136, s[20:23], s43 offen lds
    s_cmp_eq_u32 s53, 1
    s_cbranch_scc0 Lk1_gr15
    ds_read_b128 v[132:135], v13 offset:480
Lk1_gr15:
    ds_read_b128 v[92:95], v123 offset:0
    ds_read_b64_tr_b16 v[76:77], v124 offset:21504
    ds_read_b64_tr_b16 v[78:79], v124 offset:23296
    ds_read_b64_tr_b16 v[80:81], v124 offset:21560
    ds_read_b64_tr_b16 v[82:83], v124 offset:23352
    ds_read_b64_tr_b16 v[84:85], v124 offset:21616
    ds_read_b64_tr_b16 v[86:87], v124 offset:23408
    s_waitcnt lgkmcnt(7)
    s_cmp_eq_u32 s53, 1
    s_cbranch_scc0 Lk1_ng14
    v_cndmask_b32 v64, v64, v128, s[54:55]
    v_cndmask_b32 v65, v65, v129, s[54:55]
    v_cndmask_b32 v66, v66, v130, s[54:55]
    v_cndmask_b32 v67, v67, v131, s[54:55]
    s_nop 1
Lk1_ng14:
    v_mfma_f32_32x32x16_bf16 v[16:31], v[64:67], v[88:91], v[16:31]
    v_mfma_f32_32x32x16_bf16 v[32:47], v[68:71], v[88:91], v[32:47]
    v_mfma_f32_32x32x16_bf16 v[48:63], v[72:75], v[88:91], v[48:63]
    s_add_u32 s43, s42, 860160
    s_add_u32 m0, s45, 65536
    s_nop 0
    buffer_load_dwordx4 v137, s[20:23], s43 offen lds
    s_add_u32 m0, s45, 73728
    s_nop 0
    buffer_load_dwordx4 v138, s[20:23], s43 offen lds
    s_waitcnt lgkmcnt(0)
    s_waitcnt vmcnt(5)
    s_barrier
    s_cmp_eq_u32 s53, 1
    s_cbranch_scc0 Lk1_gr16
    ds_read_b128 v[128:131], v13 offset:512
Lk1_gr16:
    ds_read_b128 v[88:91], v120 offset:16384
    ds_read_b64_tr_b16 v[64:65], v125 offset:0
    ds_read_b64_tr_b16 v[66:67], v125 offset:1792
    ds_read_b64_tr_b16 v[68:69], v125 offset:56
    ds_read_b64_tr_b16 v[70:71], v125 offset:1848
    ds_read_b64_tr_b16 v[72:73], v125 offset:112
    ds_read_b64_tr_b16 v[74:75], v125 offset:1904
    s_cmp_eq_u32 s53, 1
    s_cbranch_scc0 Lk1_ng15
    v_cndmask_b32 v76, v76, v132, s[54:55]
    v_cndmask_b32 v77, v77, v133, s[54:55]
    v_cndmask_b32 v78, v78, v134, s[54:55]
    v_cndmask_b32 v79, v79, v135, s[54:55]
    s_nop 1
Lk1_ng15:
    v_mfma_f32_32x32x16_bf16 v[16:31], v[76:79], v[92:95], v[16:31]
    v_mfma_f32_32x32x16_bf16 v[32:47], v[80:83], v[92:95], v[32:47]
    v_mfma_f32_32x32x16_bf16 v[48:63], v[84:87], v[92:95], v[48:63]
    s_cmp_lt_u32 s38, 4
    s_cbranch_scc0 Lk1_d6
    s_add_u32 s43, s42, 860160
    s_add_u32 m0, s45, 81920
    s_nop 0
    buffer_load_dwordx4 v139, s[20:23], s43 offen lds
Lk1_d6:
    s_cmp_eq_u32 s53, 1
    s_cbranch_scc0 Lk1_gr17
    ds_read_b128 v[132:135], v13 offset:544
Lk1_gr17:
    ds_read_b128 v[92:95], v121 offset:16384
    ds_read_b64_tr_b16 v[76:77], v125 offset:7168
    ds_read_b64_tr_b16 v[78:79], v125 offset:8960
    ds_read_b64_tr_b16 v[80:81], v125 offset:7224
    ds_read_b64_tr_b16 v[82:83], v125 offset:9016
    ds_read_b64_tr_b16 v[84:85], v125 offset:7280
    ds_read_b64_tr_b16 v[86:87], v125 offset:9072
    s_waitcnt lgkmcnt(7)
    s_cmp_eq_u32 s53, 1
    s_cbranch_scc0 Lk1_ng16
    v_cndmask_b32 v64, v64, v128, s[54:55]
    v_cndmask_b32 v65, v65, v129, s[54:55]
    v_cndmask_b32 v66, v66, v130, s[54:55]
    v_cndmask_b32 v67, v67, v131, s[54:55]
    s_nop 1
Lk1_ng16:
    v_mfma_f32_32x32x16_bf16 v[16:31], v[64:67], v[88:91], v[16:31]
    v_mfma_f32_32x32x16_bf16 v[32:47], v[68:71], v[88:91], v[32:47]
    v_mfma_f32_32x32x16_bf16 v[48:63], v[72:75], v[88:91], v[48:63]
    s_add_u32 m0, s41, 0
    s_add_u32 s43, s40, 768
    buffer_load_dwordx4 v4, s[16:19], s43 offen lds
    s_add_u32 m0, s41, 1024
    s_add_u32 s43, s40, 7936
    buffer_load_dwordx4 v5, s[16:19], s43 offen lds
    s_cmp_eq_u32 s53, 1
    s_cbranch_scc0 Lk1_gr18
    ds_read_b128 v[128:131], v13 offset:576
Lk1_gr18:
    ds_read_b128 v[88:91], v122 offset:16384
    ds_read_b64_tr_b16 v[64:65], v125 offset:14336
    ds_read_b64_tr_b16 v[66:67], v125 offset:16128
    ds_read_b64_tr_b16 v[68:69], v125 offset:14392
    ds_read_b64_tr_b16 v[70:71], v125 offset:16184
    ds_read_b64_tr_b16 v[72:73], v125 offset:14448
    ds_read_b64_tr_b16 v[74:75], v125 offset:16240
    s_waitcnt lgkmcnt(7)
    s_cmp_eq_u32 s53, 1
    s_cbranch_scc0 Lk1_ng17
    v_cndmask_b32 v76, v76, v132, s[54:55]
    v_cndmask_b32 v77, v77, v133, s[54:55]
    v_cndmask_b32 v78, v78, v134, s[54:55]
    v_cndmask_b32 v79, v79, v135, s[54:55]
    s_nop 1
Lk1_ng17:
    v_mfma_f32_32x32x16_bf16 v[16:31], v[76:79], v[92:95], v[16:31]
    v_mfma_f32_32x32x16_bf16 v[32:47], v[80:83], v[92:95], v[32:47]
    v_mfma_f32_32x32x16_bf16 v[48:63], v[84:87], v[92:95], v[48:63]
    s_add_u32 s43, s42, 1032192
    s_add_u32 m0, s45, 0
    s_nop 0
    buffer_load_dwordx4 v136, s[20:23], s43 offen lds
    s_cmp_eq_u32 s53, 1
    s_cbranch_scc0 Lk1_gr19
    ds_read_b128 v[132:135], v13 offset:608
Lk1_gr19:
    ds_read_b128 v[92:95], v123 offset:16384
    ds_read_b64_tr_b16 v[76:77], v125 offset:21504
    ds_read_b64_tr_b16 v[78:79], v125 offset:23296
    ds_read_b64_tr_b16 v[80:81], v125 offset:21560
    ds_read_b64_tr_b16 v[82:83], v125 offset:23352
    ds_read_b64_tr_b16 v[84:85], v125 offset:21616
    ds_read_b64_tr_b16 v[86:87], v125 offset:23408
    s_waitcnt lgkmcnt(7)
    s_cmp_eq_u32 s53, 1
    s_cbranch_scc0 Lk1_ng18
    v_cndmask_b32 v64, v64, v128, s[54:55]
    v_cndmask_b32 v65, v65, v129, s[54:55]
    v_cndmask_b32 v66, v66, v130, s[54:55]
    v_cndmask_b32 v67, v67, v131, s[54:55]
    s_nop 1
Lk1_ng18:
    v_mfma_f32_32x32x16_bf16 v[16:31], v[64:67], v[88:91], v[16:31]
    v_mfma_f32_32x32x16_bf16 v[32:47], v[68:71], v[88:91], v[32:47]
    v_mfma_f32_32x32x16_bf16 v[48:63], v[72:75], v[88:91], v[48:63]
    s_add_u32 s43, s42, 1032192
    s_add_u32 m0, s45, 8192
    s_nop 0
    buffer_load_dwordx4 v137, s[20:23], s43 offen lds
    s_add_u32 m0, s45, 16384
    s_nop 0
    buffer_load_dwordx4 v138, s[20:23], s43 offen lds
    s_waitcnt lgkmcnt(0)
    s_waitcnt vmcnt(5)
    s_barrier
    s_cmp_eq_u32 s53, 1
    s_cbranch_scc0 Lk1_gr20
    ds_read_b128 v[128:131], v13 offset:640
Lk1_gr20:
    ds_read_b128 v[88:91], v120 offset:32768
    ds_read_b64_tr_b16 v[64:65], v126 offset:0
    ds_read_b64_tr_b16 v[66:67], v126 offset:1792
    ds_read_b64_tr_b16 v[68:69], v126 offset:56
    ds_read_b64_tr_b16 v[70:71], v126 offset:1848
    ds_read_b64_tr_b16 v[72:73], v126 offset:112
    ds_read_b64_tr_b16 v[74:75], v126 offset:1904
    s_cmp_eq_u32 s53, 1
    s_cbranch_scc0 Lk1_ng19
    v_cndmask_b32 v76, v76, v132, s[54:55]
    v_cndmask_b32 v77, v77, v133, s[54:55]
    v_cndmask_b32 v78, v78, v134, s[54:55]
    v_cndmask_b32 v79, v79, v135, s[54:55]
    s_nop 1
Lk1_ng19:
    v_mfma_f32_32x32x16_bf16 v[16:31], v[76:79], v[92:95], v[16:31]
    v_mfma_f32_32x32x16_bf16 v[32:47], v[80:83], v[92:95], v[32:47]
    v_mfma_f32_32x32x16_bf16 v[48:63], v[84:87], v[92:95], v[48:63]
    s_cmp_lt_u32 s38, 4
    s_cbranch_scc0 Lk1_d7
    s_add_u32 s43, s42, 1032192
    s_add_u32 m0, s45, 24576
    s_nop 0
    buffer_load_dwordx4 v139, s[20:23], s43 offen lds
Lk1_d7:
    s_cmp_eq_u32 s53, 1
    s_cbranch_scc0 Lk1_gr21
    ds_read_b128 v[132:135], v13 offset:672
Lk1_gr21:
    ds_read_b128 v[92:95], v121 offset:32768
    ds_read_b64_tr_b16 v[76:77], v126 offset:7168
    ds_read_b64_tr_b16 v[78:79], v126 offset:8960
    ds_read_b64_tr_b16 v[80:81], v126 offset:7224
    ds_read_b64_tr_b16 v[82:83], v126 offset:9016
    ds_read_b64_tr_b16 v[84:85], v126 offset:7280
    ds_read_b64_tr_b16 v[86:87], v126 offset:9072
    s_waitcnt lgkmcnt(7)
    s_cmp_eq_u32 s53, 1
    s_cbranch_scc0 Lk1_ng20
    v_cndmask_b32 v64, v64, v128, s[54:55]
    v_cndmask_b32 v65, v65, v129, s[54:55]
    v_cndmask_b32 v66, v66, v130, s[54:55]
    v_cndmask_b32 v67, v67, v131, s[54:55]
    s_nop 1
Lk1_ng20:
    v_mfma_f32_32x32x16_bf16 v[16:31], v[64:67], v[88:91], v[16:31]
    v_mfma_f32_32x32x16_bf16 v[32:47], v[68:71], v[88:91], v[32:47]
    v_mfma_f32_32x32x16_bf16 v[48:63], v[72:75], v[88:91], v[48:63]
    s_cmp_eq_u32 s53, 1
    s_cbranch_scc0 Lk1_gr22
    ds_read_b128 v[128:131], v13 offset:704
Lk1_gr22:
    ds_read_b128 v[88:91], v122 offset:32768
    ds_read_b64_tr_b16 v[64:65], v126 offset:14336
    ds_read_b64_tr_b16 v[66:67], v126 offset:16128
    ds_read_b64_tr_b16 v[68:69], v126 offset:14392
    ds_read_b64_tr_b16 v[70:71], v126 offset:16184
    ds_read_b64_tr_b16 v[72:73], v126 offset:14448
    ds_read_b64_tr_b16 v[74:75], v126 offset:16240
    s_waitcnt lgkmcnt(7)
    s_cmp_eq_u32 s53, 1
    s_cbranch_scc0 Lk1_ng21
    v_cndmask_b32 v76, v76, v132, s[54:55]
    v_cndmask_b32 v77, v77, v133, s[54:55]
    v_cndmask_b32 v78, v78, v134, s[54:55]
    v_cndmask_b32 v79, v79, v135, s[54:55]
    s_nop 1
Lk1_ng21:
    v_mfma_f32_32x32x16_bf16 v[16:31], v[76:79], v[92:95], v[16:31]
    v_mfma_f32_32x32x16_bf16 v[32:47], v[80:83], v[92:95], v[32:47]
    v_mfma_f32_32x32x16_bf16 v[48:63], v[84:87], v[92:95], v[48:63]
    s_cmp_eq_u32 s53, 1
    s_cbranch_scc0 Lk1_gr23
    ds_read_b128 v[132:135], v13 offset:736
Lk1_gr23:
    ds_read_b128 v[92:95], v123 offset:32768
    ds_read_b64_tr_b16 v[76:77], v126 offset:21504
    ds_read_b64_tr_b16 v[78:79], v126 offset:23296
    ds_read_b64_tr_b16 v[80:81], v126 offset:21560
    ds_read_b64_tr_b16 v[82:83], v126 offset:23352
    ds_read_b64_tr_b16 v[84:85], v126 offset:21616
    ds_read_b64_tr_b16 v[86:87], v126 offset:23408
    s_waitcnt lgkmcnt(7)
    s_cmp_eq_u32 s53, 1
    s_cbranch_scc0 Lk1_ng22
    v_cndmask_b32 v64, v64, v128, s[54:55]
    v_cndmask_b32 v65, v65, v129, s[54:55]
    v_cndmask_b32 v66, v66, v130, s[54:55]
    v_cndmask_b32 v67, v67, v131, s[54:55]
    s_nop 1
Lk1_ng22:
    v_mfma_f32_32x32x16_bf16 v[16:31], v[64:67], v[88:91], v[16:31]
    v_mfma_f32_32x32x16_bf16 v[32:47], v[68:71], v[88:91], v[32:47]
    v_mfma_f32_32x32x16_bf16 v[48:63], v[72:75], v[88:91], v[48:63]
    s_waitcnt lgkmcnt(0)
    s_waitcnt vmcnt(0)
    s_barrier
    s_cmp_eq_u32 s53, 1
    s_cbranch_scc0 Lk1_gr24
    ds_read_b128 v[128:131], v13 offset:768
Lk1_gr24:
    ds_read_b128 v[88:91], v120 offset:0
    ds_read_b64_tr_b16 v[64:65], v124 offset:0
    ds_read_b64_tr_b16 v[66:67], v124 offset:1792
    ds_read_b64_tr_b16 v[68:69], v124 offset:56
    ds_read_b64_tr_b16 v[70:71], v124 offset:1848
    ds_read_b64_tr_b16 v[72:73], v124 offset:112
    ds_read_b64_tr_b16 v[74:75], v124 offset:1904
    s_cmp_eq_u32 s53, 1
    s_cbranch_scc0 Lk1_ng23
    v_cndmask_b32 v76, v76, v132, s[54:55]
    v_cndmask_b32 v77, v77, v133, s[54:55]
    v_cndmask_b32 v78, v78, v134, s[54:55]
    v_cndmask_b32 v79, v79, v135, s[54:55]
    s_nop 1
Lk1_ng23:
    v_mfma_f32_32x32x16_bf16 v[16:31], v[76:79], v[92:95], v[16:31]
    v_mfma_f32_32x32x16_bf16 v[32:47], v[80:83], v[92:95], v[32:47]
    v_mfma_f32_32x32x16_bf16 v[48:63], v[84:87], v[92:95], v[48:63]
    s_cmp_eq_u32 s53, 1
    s_cbranch_scc0 Lk1_gr25
    ds_read_b128 v[132:135], v13 offset:800
Lk1_gr25:
    ds_read_b128 v[92:95], v121 offset:0
    ds_read_b64_tr_b16 v[76:77], v124 offset:7168
    ds_read_b64_tr_b16 v[78:79], v124 offset:8960
    ds_read_b64_tr_b16 v[80:81], v124 offset:7224
    ds_read_b64_tr_b16 v[82:83], v124 offset:9016
    ds_read_b64_tr_b16 v[84:85], v124 offset:7280
    ds_read_b64_tr_b16 v[86:87], v124 offset:9072
    s_waitcnt lgkmcnt(7)
    s_cmp_eq_u32 s53, 1
    s_cbranch_scc0 Lk1_ng24
    v_cndmask_b32 v64, v64, v128, s[54:55]
    v_cndmask_b32 v65, v65, v129, s[54:55]
    v_cndmask_b32 v66, v66, v130, s[54:55]
    v_cndmask_b32 v67, v67, v131, s[54:55]
    s_nop 1
Lk1_ng24:
    v_mfma_f32_32x32x16_bf16 v[16:31], v[64:67], v[88:91], v[16:31]
    v_mfma_f32_32x32x16_bf16 v[32:47], v[68:71], v[88:91], v[32:47]
    v_mfma_f32_32x32x16_bf16 v[48:63], v[72:75], v[88:91], v[48:63]
    s_cmp_eq_u32 s53, 1
    s_cbranch_scc0 Lk1_gr26
    ds_read_b128 v[128:131], v13 offset:832
Lk1_gr26:
    ds_read_b128 v[88:91], v122 offset:0
    ds_read_b64_tr_b16 v[64:65], v124 offset:14336
    ds_read_b64_tr_b16 v[66:67], v124 offset:16128
    ds_read_b64_tr_b16 v[68:69], v124 offset:14392
    ds_read_b64_tr_b16 v[70:71], v124 offset:16184
    ds_read_b64_tr_b16 v[72:73], v124 offset:14448
    ds_read_b64_tr_b16 v[74:75], v124 offset:16240
    s_waitcnt lgkmcnt(7)
    s_cmp_eq_u32 s53, 1
    s_cbranch_scc0 Lk1_ng25
    v_cndmask_b32 v76, v76, v132, s[54:55]
    v_cndmask_b32 v77, v77, v133, s[54:55]
    v_cndmask_b32 v78, v78, v134, s[54:55]
    v_cndmask_b32 v79, v79, v135, s[54:55]
    s_nop 1
Lk1_ng25:
    v_mfma_f32_32x32x16_bf16 v[16:31], v[76:79], v[92:95], v[16:31]
    v_mfma_f32_32x32x16_bf16 v[32:47], v[80:83], v[92:95], v[32:47]
    v_mfma_f32_32x32x16_bf16 v[48:63], v[84:87], v[92:95], v[48:63]
    s_cmp_eq_u32 s53, 1
    s_cbranch_scc0 Lk1_gr27
    ds_read_b128 v[132:135], v13 offset:864
Lk1_gr27:
    ds_read_b128 v[92:95], v123 offset:0
    ds_read_b64_tr_b16 v[76:77], v124 offset:21504
    ds_read_b64_tr_b16 v[78:79], v124 offset:23296
    ds_read_b64_tr_b16 v[80:81], v124 offset:21560
    ds_read_b64_tr_b16 v[82:83], v124 offset:23352
    ds_read_b64_tr_b16 v[84:85], v124 offset:21616
    ds_read_b64_tr_b16 v[86:87], v124 offset:23408
    s_waitcnt lgkmcnt(7)
    s_cmp_eq_u32 s53, 1
    s_cbranch_scc0 Lk1_ng26
    v_cndmask_b32 v64, v64, v128, s[54:55]
    v_cndmask_b32 v65, v65, v129, s[54:55]
    v_cndmask_b32 v66, v66, v130, s[54:55]
    v_cndmask_b32 v67, v67, v131, s[54:55]
    s_nop 1
Lk1_ng26:
    v_mfma_f32_32x32x16_bf16 v[16:31], v[64:67], v[88:91], v[16:31]
    v_mfma_f32_32x32x16_bf16 v[32:47], v[68:71], v[88:91], v[32:47]
    v_mfma_f32_32x32x16_bf16 v[48:63], v[72:75], v[88:91], v[48:63]
    s_waitcnt lgkmcnt(0)
    s_cmp_eq_u32 s53, 1
    s_cbranch_scc0 Lk1_ng27
    v_cndmask_b32 v76, v76, v132, s[54:55]
    v_cndmask_b32 v77, v77, v133, s[54:55]
    v_cndmask_b32 v78, v78, v134, s[54:55]
    v_cndmask_b32 v79, v79, v135, s[54:55]
    s_nop 1
Lk1_ng27:
    v_mfma_f32_32x32x16_bf16 v[16:31], v[76:79], v[92:95], v[16:31]
    v_mfma_f32_32x32x16_bf16 v[32:47], v[80:83], v[92:95], v[32:47]
    v_mfma_f32_32x32x16_bf16 v[48:63], v[84:87], v[92:95], v[48:63]
    s_nop 15
    s_cmp_eq_u32 s53, 1
    s_cbranch_scc0 Lk1_nogate2
    v_cvt_pk_bf16_f32 v10, v28, v28
    v_lshlrev_b32 v10, 16, v10
    v_mul_f32 v10, 3216550459, v10
    v_exp_f32 v10, v10
    s_nop 0
    v_add_f32 v10, 1.0, v10
    v_rcp_f32 v10, v10
    s_nop 0
    v_cvt_pk_bf16_f32 v10, v10, v10
    v_lshlrev_b32 v10, 16, v10
    v_and_b32 v3, 31, v2
    v_lshlrev_b32 v3, 2, v3
    s_lshl_b32 s44, s39, 7
    s_add_u32 s44, s44, 16777216
    s_mov_b32 exec_lo, 0
    buffer_store_dword v10, v3, s[24:27], s44 offen
    s_mov_b32 exec_lo, -1
Lk1_nogate2:
    s_add_u32 s43, s58, 0
    s_lshr_b32 s44, s43, 4
    s_and_b32 s43, s43, 15
    s_lshl_b32 s46, s36, 4
    s_add_u32 s43, s43, s46
    s_lshl_b32 s43, s43, 6
    s_add_u32 s43, s43, s39
    s_lshl_b32 s43, s43, 11
    s_lshl_b32 s46, s44, 22
    s_add_u32 s43, s43, s46
    s_cmp_eq_u32 s44, 0
    s_cselect_b32 s52, 1049335798, 1.0
    v_mul_f32 v16, s52, v16
    v_mul_f32 v17, s52, v17
    v_mul_f32 v18, s52, v18
    v_mul_f32 v19, s52, v19
    v_mul_f32 v20, s52, v20
    v_mul_f32 v21, s52, v21
    v_mul_f32 v22, s52, v22
    v_mul_f32 v23, s52, v23
    v_mul_f32 v24, s52, v24
    v_mul_f32 v25, s52, v25
    v_mul_f32 v26, s52, v26
    v_mul_f32 v27, s52, v27
    v_mul_f32 v28, s52, v28
    v_mul_f32 v29, s52, v29
    v_mul_f32 v30, s52, v30
    v_mul_f32 v31, s52, v31
    v_cvt_pk_bf16_f32 v96, v16, v17
    v_cvt_pk_bf16_f32 v97, v18, v19
    v_cvt_pk_bf16_f32 v98, v20, v21
    v_cvt_pk_bf16_f32 v99, v22, v23
    v_cvt_pk_bf16_f32 v100, v24, v25
    v_cvt_pk_bf16_f32 v101, v26, v27
    v_cvt_pk_bf16_f32 v102, v28, v29
    v_cvt_pk_bf16_f32 v103, v30, v31
    v_cndmask_b32 v102, 0, v102, s[48:49]
    v_cndmask_b32 v103, 0, v103, s[48:49]
    buffer_store_dwordx4 v[96:99], v12, s[24:27], s43 offen sc0 sc1
    buffer_store_dwordx4 v[100:103], v12, s[24:27], s43 offen offset:1024 sc0 sc1
    s_add_u32 s43, s58, 1
    s_lshr_b32 s44, s43, 4
    s_and_b32 s43, s43, 15
    s_lshl_b32 s46, s36, 4
    s_add_u32 s43, s43, s46
    s_lshl_b32 s43, s43, 6
    s_add_u32 s43, s43, s39
    s_lshl_b32 s43, s43, 11
    s_lshl_b32 s46, s44, 22
    s_add_u32 s43, s43, s46
    s_cmp_eq_u32 s44, 0
    s_cselect_b32 s52, 1049335798, 1.0
    v_mul_f32 v32, s52, v32
    v_mul_f32 v33, s52, v33
    v_mul_f32 v34, s52, v34
    v_mul_f32 v35, s52, v35
    v_mul_f32 v36, s52, v36
    v_mul_f32 v37, s52, v37
    v_mul_f32 v38, s52, v38
    v_mul_f32 v39, s52, v39
    v_mul_f32 v40, s52, v40
    v_mul_f32 v41, s52, v41
    v_mul_f32 v42, s52, v42
    v_mul_f32 v43, s52, v43
    v_mul_f32 v44, s52, v44
    v_mul_f32 v45, s52, v45
    v_mul_f32 v46, s52, v46
    v_mul_f32 v47, s52, v47
    v_cvt_pk_bf16_f32 v104, v32, v33
    v_cvt_pk_bf16_f32 v105, v34, v35
    v_cvt_pk_bf16_f32 v106, v36, v37
    v_cvt_pk_bf16_f32 v107, v38, v39
    v_cvt_pk_bf16_f32 v108, v40, v41
    v_cvt_pk_bf16_f32 v109, v42, v43
    v_cvt_pk_bf16_f32 v110, v44, v45
    v_cvt_pk_bf16_f32 v111, v46, v47
    v_cndmask_b32 v110, 0, v110, s[48:49]
    v_cndmask_b32 v111, 0, v111, s[48:49]
    buffer_store_dwordx4 v[104:107], v12, s[24:27], s43 offen sc0 sc1
    buffer_store_dwordx4 v[108:111], v12, s[24:27], s43 offen offset:1024 sc0 sc1
    s_add_u32 s43, s58, 2
    s_lshr_b32 s44, s43, 4
    s_and_b32 s43, s43, 15
    s_lshl_b32 s46, s36, 4
    s_add_u32 s43, s43, s46
    s_lshl_b32 s43, s43, 6
    s_add_u32 s43, s43, s39
    s_lshl_b32 s43, s43, 11
    s_lshl_b32 s46, s44, 22
    s_add_u32 s43, s43, s46
    s_cmp_eq_u32 s44, 0
    s_cselect_b32 s52, 1049335798, 1.0
    v_mul_f32 v48, s52, v48
    v_mul_f32 v49, s52, v49
    v_mul_f32 v50, s52, v50
    v_mul_f32 v51, s52, v51
    v_mul_f32 v52, s52, v52
    v_mul_f32 v53, s52, v53
    v_mul_f32 v54, s52, v54
    v_mul_f32 v55, s52, v55
    v_mul_f32 v56, s52, v56
    v_mul_f32 v57, s52, v57
    v_mul_f32 v58, s52, v58
    v_mul_f32 v59, s52, v59
    v_mul_f32 v60, s52, v60
    v_mul_f32 v61, s52, v61
    v_mul_f32 v62, s52, v62
    v_mul_f32 v63, s52, v63
    v_cvt_pk_bf16_f32 v112, v48, v49
    v_cvt_pk_bf16_f32 v113, v50, v51
    v_cvt_pk_bf16_f32 v114, v52, v53
    v_cvt_pk_bf16_f32 v115, v54, v55
    v_cvt_pk_bf16_f32 v116, v56, v57
    v_cvt_pk_bf16_f32 v117, v58, v59
    v_cvt_pk_bf16_f32 v118, v60, v61
    v_cvt_pk_bf16_f32 v119, v62, v63
    v_cndmask_b32 v118, 0, v118, s[48:49]
    v_cndmask_b32 v119, 0, v119, s[48:49]
    buffer_store_dwordx4 v[112:115], v12, s[24:27], s43 offen sc0 sc1
    buffer_store_dwordx4 v[116:119], v12, s[24:27], s43 offen offset:1024 sc0 sc1
    s_branch Lk1_fin
Lk1_var1:
    s_waitcnt vmcnt(5)
    s_barrier
    ds_read_b128 v[88:91], v120 offset:0
    ds_read_b64_tr_b16 v[64:65], v124 offset:0
    ds_read_b64_tr_b16 v[66:67], v124 offset:1792
    ds_read_b64_tr_b16 v[68:69], v124 offset:56
    ds_read_b64_tr_b16 v[70:71], v124 offset:1848
    ds_read_b64_tr_b16 v[72:73], v124 offset:112
    ds_read_b64_tr_b16 v[74:75], v124 offset:1904
    ds_read_b128 v[92:95], v121 offset:0
    ds_read_b64_tr_b16 v[76:77], v124 offset:7168
    ds_read_b64_tr_b16 v[78:79], v124 offset:8960
    ds_read_b64_tr_b16 v[80:81], v124 offset:7224
    ds_read_b64_tr_b16 v[82:83], v124 offset:9016
    ds_read_b64_tr_b16 v[84:85], v124 offset:7280
    ds_read_b64_tr_b16 v[86:87], v124 offset:9072
    s_waitcnt lgkmcnt(7)
    v_mfma_f32_32x32x16_bf16 v[16:31], v[64:67], v[88:91], 0
    v_mfma_f32_32x32x16_bf16 v[32:47], v[68:71], v[88:91], 0
    v_mfma_f32_32x32x16_bf16 v[48:63], v[88:91], v[72:75], 0
    s_add_u32 m0, s41, 32768
    s_add_u32 s43, s40, 256
    buffer_load_dwordx4 v4, s[16:19], s43 offen lds
    s_add_u32 m0, s41, 33792
    s_add_u32 s43, s40, 7424
    buffer_load_dwordx4 v5, s[16:19], s43 offen lds
    ds_read_b128 v[88:91], v122 offset:0
    ds_read_b64_tr_b16 v[64:65], v124 offset:14336
    ds_read_b64_tr_b16 v[66:67], v124 offset:16128
    ds_read_b64_tr_b16 v[68:69], v124 offset:14392
    ds_read_b64_tr_b16 v[70:71], v124 offset:16184
    ds_read_b64_tr_b16 v[72:73], v124 offset:14448
    ds_read_b64_tr_b16 v[74:75], v124 offset:16240
    s_waitcnt lgkmcnt(7)
    v_mfma_f32_32x32x16_bf16 v[16:31], v[76:79], v[92:95], v[16:31]
    v_mfma_f32_32x32x16_bf16 v[32:47], v[80:83], v[92:95], v[32:47]
    v_mfma_f32_32x32x16_bf16 v[48:63], v[92:95], v[84:87], v[48:63]
    s_add_u32 s43, s42, 344064
    s_add_u32 m0, s45, 57344
    s_nop 0
    buffer_load_dwordx4 v136, s[20:23], s43 offen lds
    ds_read_b128 v[92:95], v123 offset:0
    ds_read_b64_tr_b16 v[76:77], v124 offset:21504
    ds_read_b64_tr_b16 v[78:79], v124 offset:23296
    ds_read_b64_tr_b16 v[80:81], v124 offset:21560
    ds_read_b64_tr_b16 v[82:83], v124 offset:23352
    ds_read_b64_tr_b16 v[84:85], v124 offset:21616
    ds_read_b64_tr_b16 v[86:87], v124 offset:23408
    s_waitcnt lgkmcnt(7)
    v_mfma_f32_32x32x16_bf16 v[16:31], v[64:67], v[88:91], v[16:31]
    v_mfma_f32_32x32x16_bf16 v[32:47], v[68:71], v[88:91], v[32:47]
    v_mfma_f32_32x32x16_bf16 v[48:63], v[88:91], v[72:75], v[48:63]
    s_add_u32 s43, s42, 344064
    s_add_u32 m0, s45, 65536
    s_nop 0
    buffer_load_dwordx4 v137, s[20:23], s43 offen lds
    s_add_u32 m0, s45, 73728
    s_nop 0
    buffer_load_dwordx4 v138, s[20:23], s43 offen lds
    s_waitcnt lgkmcnt(0)
    s_waitcnt vmcnt(5)
    s_barrier
    ds_read_b128 v[88:91], v120 offset:16384
    ds_read_b64_tr_b16 v[64:65], v125 offset:0
    ds_read_b64_tr_b16 v[66:67], v125 offset:1792
    ds_read_b64_tr_b16 v[68:69], v125 offset:56
    ds_read_b64_tr_b16 v[70:71], v125 offset:1848
    ds_read_b64_tr_b16 v[72:73], v125 offset:112
    ds_read_b64_tr_b16 v[74:75], v125 offset:1904
    v_mfma_f32_32x32x16_bf16 v[16:31], v[76:79], v[92:95], v[16:31]
    v_mfma_f32_32x32x16_bf16 v[32:47], v[80:83], v[92:95], v[32:47]
    v_mfma_f32_32x32x16_bf16 v[48:63], v[92:95], v[84:87], v[48:63]
    s_cmp_lt_u32 s38, 4
    s_cbranch_scc0 Lk1_d8
    s_add_u32 s43, s42, 344064
    s_add_u32 m0, s45, 81920
    s_nop 0
    buffer_load_dwordx4 v139, s[20:23], s43 offen lds
Lk1_d8:
    ds_read_b128 v[92:95], v121 offset:16384
    ds_read_b64_tr_b16 v[76:77], v125 offset:7168
    ds_read_b64_tr_b16 v[78:79], v125 offset:8960
    ds_read_b64_tr_b16 v[80:81], v125 offset:7224
    ds_read_b64_tr_b16 v[82:83], v125 offset:9016
    ds_read_b64_tr_b16 v[84:85], v125 offset:7280
    ds_read_b64_tr_b16 v[86:87], v125 offset:9072
    s_waitcnt lgkmcnt(7)
    v_mfma_f32_32x32x16_bf16 v[16:31], v[64:67], v[88:91], v[16:31]
    v_mfma_f32_32x32x16_bf16 v[32:47], v[68:71], v[88:91], v[32:47]
    v_mfma_f32_32x32x16_bf16 v[48:63], v[88:91], v[72:75], v[48:63]
    s_add_u32 m0, s41, 0
    s_add_u32 s43, s40, 384
    buffer_load_dwordx4 v4, s[16:19], s43 offen lds
    s_add_u32 m0, s41, 1024
    s_add_u32 s43, s40, 7552
    buffer_load_dwordx4 v5, s[16:19], s43 offen lds
    ds_read_b128 v[88:91], v122 offset:16384
    ds_read_b64_tr_b16 v[64:65], v125 offset:14336
    ds_read_b64_tr_b16 v[66:67], v125 offset:16128
    ds_read_b64_tr_b16 v[68:69], v125 offset:14392
    ds_read_b64_tr_b16 v[70:71], v125 offset:16184
    ds_read_b64_tr_b16 v[72:73], v125 offset:14448
    ds_read_b64_tr_b16 v[74:75], v125 offset:16240
    s_waitcnt lgkmcnt(7)
    v_mfma_f32_32x32x16_bf16 v[16:31], v[76:79], v[92:95], v[16:31]
    v_mfma_f32_32x32x16_bf16 v[32:47], v[80:83], v[92:95], v[32:47]
    v_mfma_f32_32x32x16_bf16 v[48:63], v[92:95], v[84:87], v[48:63]
    s_add_u32 s43, s42, 516096
    s_add_u32 m0, s45, 0
    s_nop 0
    buffer_load_dwordx4 v136, s[20:23], s43 offen lds
    ds_read_b128 v[92:95], v123 offset:16384
    ds_read_b64_tr_b16 v[76:77], v125 offset:21504
    ds_read_b64_tr_b16 v[78:79], v125 offset:23296
    ds_read_b64_tr_b16 v[80:81], v125 offset:21560
    ds_read_b64_tr_b16 v[82:83], v125 offset:23352
    ds_read_b64_tr_b16 v[84:85], v125 offset:21616
    ds_read_b64_tr_b16 v[86:87], v125 offset:23408
    s_waitcnt lgkmcnt(7)
    v_mfma_f32_32x32x16_bf16 v[16:31], v[64:67], v[88:91], v[16:31]
    v_mfma_f32_32x32x16_bf16 v[32:47], v[68:71], v[88:91], v[32:47]
    v_mfma_f32_32x32x16_bf16 v[48:63], v[88:91], v[72:75], v[48:63]
    s_add_u32 s43, s42, 516096
    s_add_u32 m0, s45, 8192
    s_nop 0
    buffer_load_dwordx4 v137, s[20:23], s43 offen lds
    s_add_u32 m0, s45, 16384
    s_nop 0
    buffer_load_dwordx4 v138, s[20:23], s43 offen lds
    s_waitcnt lgkmcnt(0)
    s_waitcnt vmcnt(5)
    s_barrier
    ds_read_b128 v[88:91], v120 offset:32768
    ds_read_b64_tr_b16 v[64:65], v126 offset:0
    ds_read_b64_tr_b16 v[66:67], v126 offset:1792
    ds_read_b64_tr_b16 v[68:69], v126 offset:56
    ds_read_b64_tr_b16 v[70:71], v126 offset:1848
    ds_read_b64_tr_b16 v[72:73], v126 offset:112
    ds_read_b64_tr_b16 v[74:75], v126 offset:1904
    v_mfma_f32_32x32x16_bf16 v[16:31], v[76:79], v[92:95], v[16:31]
    v_mfma_f32_32x32x16_bf16 v[32:47], v[80:83], v[92:95], v[32:47]
    v_mfma_f32_32x32x16_bf16 v[48:63], v[92:95], v[84:87], v[48:63]
    s_cmp_lt_u32 s38, 4
    s_cbranch_scc0 Lk1_d9
    s_add_u32 s43, s42, 516096
    s_add_u32 m0, s45, 24576
    s_nop 0
    buffer_load_dwordx4 v139, s[20:23], s43 offen lds
Lk1_d9:
    ds_read_b128 v[92:95], v121 offset:32768
    ds_read_b64_tr_b16 v[76:77], v126 offset:7168
    ds_read_b64_tr_b16 v[78:79], v126 offset:8960
    ds_read_b64_tr_b16 v[80:81], v126 offset:7224
    ds_read_b64_tr_b16 v[82:83], v126 offset:9016
    ds_read_b64_tr_b16 v[84:85], v126 offset:7280
    ds_read_b64_tr_b16 v[86:87], v126 offset:9072
    s_waitcnt lgkmcnt(7)
    v_mfma_f32_32x32x16_bf16 v[16:31], v[64:67], v[88:91], v[16:31]
    v_mfma_f32_32x32x16_bf16 v[32:47], v[68:71], v[88:91], v[32:47]
    v_mfma_f32_32x32x16_bf16 v[48:63], v[88:91], v[72:75], v[48:63]
    s_add_u32 m0, s41, 16384
    s_add_u32 s43, s40, 512
    buffer_load_dwordx4 v4, s[16:19], s43 offen lds
    s_add_u32 m0, s41, 17408
    s_add_u32 s43, s40, 7680
    buffer_load_dwordx4 v5, s[16:19], s43 offen lds
    ds_read_b128 v[88:91], v122 offset:32768
    ds_read_b64_tr_b16 v[64:65], v126 offset:14336
    ds_read_b64_tr_b16 v[66:67], v126 offset:16128
    ds_read_b64_tr_b16 v[68:69], v126 offset:14392
    ds_read_b64_tr_b16 v[70:71], v126 offset:16184
    ds_read_b64_tr_b16 v[72:73], v126 offset:14448
    ds_read_b64_tr_b16 v[74:75], v126 offset:16240
    s_waitcnt lgkmcnt(7)
    v_mfma_f32_32x32x16_bf16 v[16:31], v[76:79], v[92:95], v[16:31]
    v_mfma_f32_32x32x16_bf16 v[32:47], v[80:83], v[92:95], v[32:47]
    v_mfma_f32_32x32x16_bf16 v[48:63], v[92:95], v[84:87], v[48:63]
    s_add_u32 s43, s42, 688128
    s_add_u32 m0, s45, 28672
    s_nop 0
    buffer_load_dwordx4 v136, s[20:23], s43 offen lds
    ds_read_b128 v[92:95], v123 offset:32768
    ds_read_b64_tr_b16 v[76:77], v126 offset:21504
    ds_read_b64_tr_b16 v[78:79], v126 offset:23296
    ds_read_b64_tr_b16 v[80:81], v126 offset:21560
    ds_read_b64_tr_b16 v[82:83], v126 offset:23352
    ds_read_b64_tr_b16 v[84:85], v126 offset:21616
    ds_read_b64_tr_b16 v[86:87], v126 offset:23408
    s_waitcnt lgkmcnt(7)
    v_mfma_f32_32x32x16_bf16 v[16:31], v[64:67], v[88:91], v[16:31]
    v_mfma_f32_32x32x16_bf16 v[32:47], v[68:71], v[88:91], v[32:47]
    v_mfma_f32_32x32x16_bf16 v[48:63], v[88:91], v[72:75], v[48:63]
    s_add_u32 s43, s42, 688128
    s_add_u32 m0, s45, 36864
    s_nop 0
    buffer_load_dwordx4 v137, s[20:23], s43 offen lds
    s_add_u32 m0, s45, 45056
    s_nop 0
    buffer_load_dwordx4 v138, s[20:23], s43 offen lds
    s_waitcnt lgkmcnt(0)
    s_waitcnt vmcnt(5)
    s_barrier
    ds_read_b128 v[88:91], v120 offset:0
    ds_read_b64_tr_b16 v[64:65], v124 offset:0
    ds_read_b64_tr_b16 v[66:67], v124 offset:1792
    ds_read_b64_tr_b16 v[68:69], v124 offset:56
    ds_read_b64_tr_b16 v[70:71], v124 offset:1848
    ds_read_b64_tr_b16 v[72:73], v124 offset:112
    ds_read_b64_tr_b16 v[74:75], v124 offset:1904
    v_mfma_f32_32x32x16_bf16 v[16:31], v[76:79], v[92:95], v[16:31]
    v_mfma_f32_32x32x16_bf16 v[32:47], v[80:83], v[92:95], v[32:47]
    v_mfma_f32_32x32x16_bf16 v[48:63], v[92:95], v[84:87], v[48:63]
    s_cmp_lt_u32 s38, 4
    s_cbranch_scc0 Lk1_d10
    s_add_u32 s43, s42, 688128
    s_add_u32 m0, s45, 53248
    s_nop 0
    buffer_load_dwordx4 v139, s[20:23], s43 offen lds
Lk1_d10:
    ds_read_b128 v[92:95], v121 offset:0
    ds_read_b64_tr_b16 v[76:77], v124 offset:7168
    ds_read_b64_tr_b16 v[78:79], v124 offset:8960
    ds_read_b64_tr_b16 v[80:81], v124 offset:7224
    ds_read_b64_tr_b16 v[82:83], v124 offset:9016
    ds_read_b64_tr_b16 v[84:85], v124 offset:7280
    ds_read_b64_tr_b16 v[86:87], v124 offset:9072
    s_waitcnt lgkmcnt(7)
    v_mfma_f32_32x32x16_bf16 v[16:31], v[64:67], v[88:91], v[16:31]
    v_mfma_f32_32x32x16_bf16 v[32:47], v[68:71], v[88:91], v[32:47]
    v_mfma_f32_32x32x16_bf16 v[48:63], v[88:91], v[72:75], v[48:63]
    s_add_u32 m0, s41, 32768
    s_add_u32 s43, s40, 640
    buffer_load_dwordx4 v4, s[16:19], s43 offen lds
    s_add_u32 m0, s41, 33792
    s_add_u32 s43, s40, 7808
    buffer_load_dwordx4 v5, s[16:19], s43 offen lds
    ds_read_b128 v[88:91], v122 offset:0
    ds_read_b64_tr_b16 v[64:65], v124 offset:14336
    ds_read_b64_tr_b16 v[66:67], v124 offset:16128
    ds_read_b64_tr_b16 v[68:69], v124 offset:14392
    ds_read_b64_tr_b16 v[70:71], v124 offset:16184
    ds_read_b64_tr_b16 v[72:73], v124 offset:14448
    ds_read_b64_tr_b16 v[74:75], v124 offset:16240
    s_waitcnt lgkmcnt(7)
    v_mfma_f32_32x32x16_bf16 v[16:31], v[76:79], v[92:95], v[16:31]
    v_mfma_f32_32x32x16_bf16 v[32:47], v[80:83], v[92:95], v[32:47]
    v_mfma_f32_32x32x16_bf16 v[48:63], v[92:95], v[84:87], v[48:63]
    s_add_u32 s43, s42, 860160
    s_add_u32 m0, s45, 57344
    s_nop 0
    buffer_load_dwordx4 v136, s[20:23], s43 offen lds
    ds_read_b128 v[92:95], v123 offset:0
    ds_read_b64_tr_b16 v[76:77], v124 offset:21504
    ds_read_b64_tr_b16 v[78:79], v124 offset:23296
    ds_read_b64_tr_b16 v[80:81], v124 offset:21560
    ds_read_b64_tr_b16 v[82:83], v124 offset:23352
    ds_read_b64_tr_b16 v[84:85], v124 offset:21616
    ds_read_b64_tr_b16 v[86:87], v124 offset:23408
    s_waitcnt lgkmcnt(7)
    v_mfma_f32_32x32x16_bf16 v[16:31], v[64:67], v[88:91], v[16:31]
    v_mfma_f32_32x32x16_bf16 v[32:47], v[68:71], v[88:91], v[32:47]
    v_mfma_f32_32x32x16_bf16 v[48:63], v[88:91], v[72:75], v[48:63]
    s_add_u32 s43, s42, 860160
    s_add_u32 m0, s45, 65536
    s_nop 0
    buffer_load_dwordx4 v137, s[20:23], s43 offen lds
    s_add_u32 m0, s45, 73728
    s_nop 0
    buffer_load_dwordx4 v138, s[20:23], s43 offen lds
    s_waitcnt lgkmcnt(0)
    s_waitcnt vmcnt(5)
    s_barrier
    ds_read_b128 v[88:91], v120 offset:16384
    ds_read_b64_tr_b16 v[64:65], v125 offset:0
    ds_read_b64_tr_b16 v[66:67], v125 offset:1792
    ds_read_b64_tr_b16 v[68:69], v125 offset:56
    ds_read_b64_tr_b16 v[70:71], v125 offset:1848
    ds_read_b64_tr_b16 v[72:73], v125 offset:112
    ds_read_b64_tr_b16 v[74:75], v125 offset:1904
    v_mfma_f32_32x32x16_bf16 v[16:31], v[76:79], v[92:95], v[16:31]
    v_mfma_f32_32x32x16_bf16 v[32:47], v[80:83], v[92:95], v[32:47]
    v_mfma_f32_32x32x16_bf16 v[48:63], v[92:95], v[84:87], v[48:63]
    s_cmp_lt_u32 s38, 4
    s_cbranch_scc0 Lk1_d11
    s_add_u32 s43, s42, 860160
    s_add_u32 m0, s45, 81920
    s_nop 0
    buffer_load_dwordx4 v139, s[20:23], s43 offen lds
Lk1_d11:
    ds_read_b128 v[92:95], v121 offset:16384
    ds_read_b64_tr_b16 v[76:77], v125 offset:7168
    ds_read_b64_tr_b16 v[78:79], v125 offset:8960
    ds_read_b64_tr_b16 v[80:81], v125 offset:7224
    ds_read_b64_tr_b16 v[82:83], v125 offset:9016
    ds_read_b64_tr_b16 v[84:85], v125 offset:7280
    ds_read_b64_tr_b16 v[86:87], v125 offset:9072
    s_waitcnt lgkmcnt(7)
    v_mfma_f32_32x32x16_bf16 v[16:31], v[64:67], v[88:91], v[16:31]
    v_mfma_f32_32x32x16_bf16 v[32:47], v[68:71], v[88:91], v[32:47]
    v_mfma_f32_32x32x16_bf16 v[48:63], v[88:91], v[72:75], v[48:63]
    s_add_u32 m0, s41, 0
    s_add_u32 s43, s40, 768
    buffer_load_dwordx4 v4, s[16:19], s43 offen lds
    s_add_u32 m0, s41, 1024
    s_add_u32 s43, s40, 7936
    buffer_load_dwordx4 v5, s[16:19], s43 offen lds
    ds_read_b128 v[88:91], v122 offset:16384
    ds_read_b64_tr_b16 v[64:65], v125 offset:14336
    ds_read_b64_tr_b16 v[66:67], v125 offset:16128
    ds_read_b64_tr_b16 v[68:69], v125 offset:14392
    ds_read_b64_tr_b16 v[70:71], v125 offset:16184
    ds_read_b64_tr_b16 v[72:73], v125 offset:14448
    ds_read_b64_tr_b16 v[74:75], v125 offset:16240
    s_waitcnt lgkmcnt(7)
    v_mfma_f32_32x32x16_bf16 v[16:31], v[76:79], v[92:95], v[16:31]
    v_mfma_f32_32x32x16_bf16 v[32:47], v[80:83], v[92:95], v[32:47]
    v_mfma_f32_32x32x16_bf16 v[48:63], v[92:95], v[84:87], v[48:63]
    s_add_u32 s43, s42, 1032192
    s_add_u32 m0, s45, 0
    s_nop 0
    buffer_load_dwordx4 v136, s[20:23], s43 offen lds
    ds_read_b128 v[92:95], v123 offset:16384
    ds_read_b64_tr_b16 v[76:77], v125 offset:21504
    ds_read_b64_tr_b16 v[78:79], v125 offset:23296
    ds_read_b64_tr_b16 v[80:81], v125 offset:21560
    ds_read_b64_tr_b16 v[82:83], v125 offset:23352
    ds_read_b64_tr_b16 v[84:85], v125 offset:21616
    ds_read_b64_tr_b16 v[86:87], v125 offset:23408
    s_waitcnt lgkmcnt(7)
    v_mfma_f32_32x32x16_bf16 v[16:31], v[64:67], v[88:91], v[16:31]
    v_mfma_f32_32x32x16_bf16 v[32:47], v[68:71], v[88:91], v[32:47]
    v_mfma_f32_32x32x16_bf16 v[48:63], v[88:91], v[72:75], v[48:63]
    s_add_u32 s43, s42, 1032192
    s_add_u32 m0, s45, 8192
    s_nop 0
    buffer_load_dwordx4 v137, s[20:23], s43 offen lds
    s_add_u32 m0, s45, 16384
    s_nop 0
    buffer_load_dwordx4 v138, s[20:23], s43 offen lds
    s_waitcnt lgkmcnt(0)
    s_waitcnt vmcnt(5)
    s_barrier
    ds_read_b128 v[88:91], v120 offset:32768
    ds_read_b64_tr_b16 v[64:65], v126 offset:0
    ds_read_b64_tr_b16 v[66:67], v126 offset:1792
    ds_read_b64_tr_b16 v[68:69], v126 offset:56
    ds_read_b64_tr_b16 v[70:71], v126 offset:1848
    ds_read_b64_tr_b16 v[72:73], v126 offset:112
    ds_read_b64_tr_b16 v[74:75], v126 offset:1904
    v_mfma_f32_32x32x16_bf16 v[16:31], v[76:79], v[92:95], v[16:31]
    v_mfma_f32_32x32x16_bf16 v[32:47], v[80:83], v[92:95], v[32:47]
    v_mfma_f32_32x32x16_bf16 v[48:63], v[92:95], v[84:87], v[48:63]
    s_cmp_lt_u32 s38, 4
    s_cbranch_scc0 Lk1_d12
    s_add_u32 s43, s42, 1032192
    s_add_u32 m0, s45, 24576
    s_nop 0
    buffer_load_dwordx4 v139, s[20:23], s43 offen lds
Lk1_d12:
    ds_read_b128 v[92:95], v121 offset:32768
    ds_read_b64_tr_b16 v[76:77], v126 offset:7168
    ds_read_b64_tr_b16 v[78:79], v126 offset:8960
    ds_read_b64_tr_b16 v[80:81], v126 offset:7224
    ds_read_b64_tr_b16 v[82:83], v126 offset:9016
    ds_read_b64_tr_b16 v[84:85], v126 offset:7280
    ds_read_b64_tr_b16 v[86:87], v126 offset:9072
    s_waitcnt lgkmcnt(7)
    v_mfma_f32_32x32x16_bf16 v[16:31], v[64:67], v[88:91], v[16:31]
    v_mfma_f32_32x32x16_bf16 v[32:47], v[68:71], v[88:91], v[32:47]
    v_mfma_f32_32x32x16_bf16 v[48:63], v[88:91], v[72:75], v[48:63]
    ds_read_b128 v[88:91], v122 offset:32768
    ds_read_b64_tr_b16 v[64:65], v126 offset:14336
    ds_read_b64_tr_b16 v[66:67], v126 offset:16128
    ds_read_b64_tr_b16 v[68:69], v126 offset:14392
    ds_read_b64_tr_b16 v[70:71], v126 offset:16184
    ds_read_b64_tr_b16 v[72:73], v126 offset:14448
    ds_read_b64_tr_b16 v[74:75], v126 offset:16240
    s_waitcnt lgkmcnt(7)
    v_mfma_f32_32x32x16_bf16 v[16:31], v[76:79], v[92:95], v[16:31]
    v_mfma_f32_32x32x16_bf16 v[32:47], v[80:83], v[92:95], v[32:47]
    v_mfma_f32_32x32x16_bf16 v[48:63], v[92:95], v[84:87], v[48:63]
    ds_read_b128 v[92:95], v123 offset:32768
    ds_read_b64_tr_b16 v[76:77], v126 offset:21504
    ds_read_b64_tr_b16 v[78:79], v126 offset:23296
    ds_read_b64_tr_b16 v[80:81], v126 offset:21560
    ds_read_b64_tr_b16 v[82:83], v126 offset:23352
    ds_read_b64_tr_b16 v[84:85], v126 offset:21616
    ds_read_b64_tr_b16 v[86:87], v126 offset:23408
    s_waitcnt lgkmcnt(7)
    v_mfma_f32_32x32x16_bf16 v[16:31], v[64:67], v[88:91], v[16:31]
    v_mfma_f32_32x32x16_bf16 v[32:47], v[68:71], v[88:91], v[32:47]
    v_mfma_f32_32x32x16_bf16 v[48:63], v[88:91], v[72:75], v[48:63]
    s_waitcnt lgkmcnt(0)
    s_waitcnt vmcnt(0)
    s_barrier
    ds_read_b128 v[88:91], v120 offset:0
    ds_read_b64_tr_b16 v[64:65], v124 offset:0
    ds_read_b64_tr_b16 v[66:67], v124 offset:1792
    ds_read_b64_tr_b16 v[68:69], v124 offset:56
    ds_read_b64_tr_b16 v[70:71], v124 offset:1848
    ds_read_b64_tr_b16 v[72:73], v124 offset:112
    ds_read_b64_tr_b16 v[74:75], v124 offset:1904
    v_mfma_f32_32x32x16_bf16 v[16:31], v[76:79], v[92:95], v[16:31]
    v_mfma_f32_32x32x16_bf16 v[32:47], v[80:83], v[92:95], v[32:47]
    v_mfma_f32_32x32x16_bf16 v[48:63], v[92:95], v[84:87], v[48:63]
    ds_read_b128 v[92:95], v121 offset:0
    ds_read_b64_tr_b16 v[76:77], v124 offset:7168
    ds_read_b64_tr_b16 v[78:79], v124 offset:8960
    ds_read_b64_tr_b16 v[80:81], v124 offset:7224
    ds_read_b64_tr_b16 v[82:83], v124 offset:9016
    ds_read_b64_tr_b16 v[84:85], v124 offset:7280
    ds_read_b64_tr_b16 v[86:87], v124 offset:9072
    s_waitcnt lgkmcnt(7)
    v_mfma_f32_32x32x16_bf16 v[16:31], v[64:67], v[88:91], v[16:31]
    v_mfma_f32_32x32x16_bf16 v[32:47], v[68:71], v[88:91], v[32:47]
    v_mfma_f32_32x32x16_bf16 v[48:63], v[88:91], v[72:75], v[48:63]
    ds_read_b128 v[88:91], v122 offset:0
    ds_read_b64_tr_b16 v[64:65], v124 offset:14336
    ds_read_b64_tr_b16 v[66:67], v124 offset:16128
    ds_read_b64_tr_b16 v[68:69], v124 offset:14392
    ds_read_b64_tr_b16 v[70:71], v124 offset:16184
    ds_read_b64_tr_b16 v[72:73], v124 offset:14448
    ds_read_b64_tr_b16 v[74:75], v124 offset:16240
    s_waitcnt lgkmcnt(7)
    v_mfma_f32_32x32x16_bf16 v[16:31], v[76:79], v[92:95], v[16:31]
    v_mfma_f32_32x32x16_bf16 v[32:47], v[80:83], v[92:95], v[32:47]
    v_mfma_f32_32x32x16_bf16 v[48:63], v[92:95], v[84:87], v[48:63]
    ds_read_b128 v[92:95], v123 offset:0
    ds_read_b64_tr_b16 v[76:77], v124 offset:21504
    ds_read_b64_tr_b16 v[78:79], v124 offset:23296
    ds_read_b64_tr_b16 v[80:81], v124 offset:21560
    ds_read_b64_tr_b16 v[82:83], v124 offset:23352
    ds_read_b64_tr_b16 v[84:85], v124 offset:21616
    ds_read_b64_tr_b16 v[86:87], v124 offset:23408
    s_waitcnt lgkmcnt(7)
    v_mfma_f32_32x32x16_bf16 v[16:31], v[64:67], v[88:91], v[16:31]
    v_mfma_f32_32x32x16_bf16 v[32:47], v[68:71], v[88:91], v[32:47]
    v_mfma_f32_32x32x16_bf16 v[48:63], v[88:91], v[72:75], v[48:63]
    s_waitcnt lgkmcnt(0)
    v_mfma_f32_32x32x16_bf16 v[16:31], v[76:79], v[92:95], v[16:31]
    v_mfma_f32_32x32x16_bf16 v[32:47], v[80:83], v[92:95], v[32:47]
    v_mfma_f32_32x32x16_bf16 v[48:63], v[92:95], v[84:87], v[48:63]
    s_nop 15
    s_add_u32 s43, s58, 0
    s_lshr_b32 s44, s43, 4
    s_and_b32 s43, s43, 15
    s_lshl_b32 s46, s36, 4
    s_add_u32 s43, s43, s46
    s_lshl_b32 s43, s43, 6
    s_add_u32 s43, s43, s39
    s_lshl_b32 s43, s43, 11
    s_lshl_b32 s46, s44, 22
    s_add_u32 s43, s43, s46
    s_cmp_eq_u32 s44, 0
    s_cselect_b32 s52, 1049335798, 1.0
    v_mul_f32 v16, s52, v16
    v_mul_f32 v17, s52, v17
    v_mul_f32 v18, s52, v18
    v_mul_f32 v19, s52, v19
    v_mul_f32 v20, s52, v20
    v_mul_f32 v21, s52, v21
    v_mul_f32 v22, s52, v22
    v_mul_f32 v23, s52, v23
    v_mul_f32 v24, s52, v24
    v_mul_f32 v25, s52, v25
    v_mul_f32 v26, s52, v26
    v_mul_f32 v27, s52, v27
    v_mul_f32 v28, s52, v28
    v_mul_f32 v29, s52, v29
    v_mul_f32 v30, s52, v30
    v_mul_f32 v31, s52, v31
    v_cvt_pk_bf16_f32 v96, v16, v17
    v_cvt_pk_bf16_f32 v97, v18, v19
    v_cvt_pk_bf16_f32 v98, v20, v21
    v_cvt_pk_bf16_f32 v99, v22, v23
    v_cvt_pk_bf16_f32 v100, v24, v25
    v_cvt_pk_bf16_f32 v101, v26, v27
    v_cvt_pk_bf16_f32 v102, v28, v29
    v_cvt_pk_bf16_f32 v103, v30, v31
    v_cndmask_b32 v102, 0, v102, s[48:49]
    v_cndmask_b32 v103, 0, v103, s[48:49]
    buffer_store_dwordx4 v[96:99], v12, s[24:27], s43 offen sc0 sc1
    buffer_store_dwordx4 v[100:103], v12, s[24:27], s43 offen offset:1024 sc0 sc1
    s_add_u32 s43, s58, 1
    s_lshr_b32 s44, s43, 4
    s_and_b32 s43, s43, 15
    s_lshl_b32 s46, s36, 4
    s_add_u32 s43, s43, s46
    s_lshl_b32 s43, s43, 6
    s_add_u32 s43, s43, s39
    s_lshl_b32 s43, s43, 11
    s_lshl_b32 s46, s44, 22
    s_add_u32 s43, s43, s46
    s_cmp_eq_u32 s44, 0
    s_cselect_b32 s52, 1049335798, 1.0
    v_mul_f32 v32, s52, v32
    v_mul_f32 v33, s52, v33
    v_mul_f32 v34, s52, v34
    v_mul_f32 v35, s52, v35
    v_mul_f32 v36, s52, v36
    v_mul_f32 v37, s52, v37
    v_mul_f32 v38, s52, v38
    v_mul_f32 v39, s52, v39
    v_mul_f32 v40, s52, v40
    v_mul_f32 v41, s52, v41
    v_mul_f32 v42, s52, v42
    v_mul_f32 v43, s52, v43
    v_mul_f32 v44, s52, v44
    v_mul_f32 v45, s52, v45
    v_mul_f32 v46, s52, v46
    v_mul_f32 v47, s52, v47
    v_cvt_pk_bf16_f32 v104, v32, v33
    v_cvt_pk_bf16_f32 v105, v34, v35
    v_cvt_pk_bf16_f32 v106, v36, v37
    v_cvt_pk_bf16_f32 v107, v38, v39
    v_cvt_pk_bf16_f32 v108, v40, v41
    v_cvt_pk_bf16_f32 v109, v42, v43
    v_cvt_pk_bf16_f32 v110, v44, v45
    v_cvt_pk_bf16_f32 v111, v46, v47
    v_cndmask_b32 v110, 0, v110, s[48:49]
    v_cndmask_b32 v111, 0, v111, s[48:49]
    buffer_store_dwordx4 v[104:107], v12, s[24:27], s43 offen sc0 sc1
    buffer_store_dwordx4 v[108:111], v12, s[24:27], s43 offen offset:1024 sc0 sc1
    s_add_u32 s43, s58, 2
    s_lshr_b32 s44, s43, 4
    s_and_b32 s43, s43, 15
    s_lshl_b32 s46, s36, 4
    s_add_u32 s43, s43, s46
    s_lshl_b32 s43, s43, 6
    s_add_u32 s43, s43, s39
    s_lshl_b32 s43, s43, 11
    s_lshl_b32 s46, s44, 22
    s_add_u32 s43, s43, s46
    v_cvt_pk_bf16_f32 v112, v48, v49
    v_cvt_pk_bf16_f32 v113, v50, v51
    v_cvt_pk_bf16_f32 v114, v52, v53
    v_cvt_pk_bf16_f32 v115, v54, v55
    v_cvt_pk_bf16_f32 v116, v56, v57
    v_cvt_pk_bf16_f32 v117, v58, v59
    v_cvt_pk_bf16_f32 v118, v60, v61
    v_cvt_pk_bf16_f32 v119, v62, v63
    v_cndmask_b32 v112, v9, v112, s[50:51]
    v_cndmask_b32 v113, v9, v113, s[50:51]
    v_cndmask_b32 v114, v9, v114, s[50:51]
    v_cndmask_b32 v115, v9, v115, s[50:51]
    v_cndmask_b32 v116, v9, v116, s[50:51]
    v_cndmask_b32 v117, v9, v117, s[50:51]
    v_cndmask_b32 v118, v9, v118, s[50:51]
    v_cndmask_b32 v119, v9, v119, s[50:51]
    buffer_store_dwordx4 v[112:115], v12, s[24:27], s43 offen sc0 sc1
    buffer_store_dwordx4 v[116:119], v12, s[24:27], s43 offen offset:1024 sc0 sc1
    s_branch Lk1_fin
Lk1_var2:
    s_waitcnt vmcnt(5)
    s_barrier
    ds_read_b128 v[88:91], v120 offset:0
    ds_read_b64_tr_b16 v[64:65], v124 offset:0
    ds_read_b64_tr_b16 v[66:67], v124 offset:1792
    ds_read_b64_tr_b16 v[68:69], v124 offset:56
    ds_read_b64_tr_b16 v[70:71], v124 offset:1848
    ds_read_b64_tr_b16 v[72:73], v124 offset:112
    ds_read_b64_tr_b16 v[74:75], v124 offset:1904
    ds_read_b128 v[92:95], v121 offset:0
    ds_read_b64_tr_b16 v[76:77], v124 offset:7168
    ds_read_b64_tr_b16 v[78:79], v124 offset:8960
    ds_read_b64_tr_b16 v[80:81], v124 offset:7224
    ds_read_b64_tr_b16 v[82:83], v124 offset:9016
    ds_read_b64_tr_b16 v[84:85], v124 offset:7280
    ds_read_b64_tr_b16 v[86:87], v124 offset:9072
    s_waitcnt lgkmcnt(7)
    v_mfma_f32_32x32x16_bf16 v[16:31], v[88:91], v[64:67], 0
    v_mfma_f32_32x32x16_bf16 v[32:47], v[88:91], v[68:71], 0
    v_mfma_f32_32x32x16_bf16 v[48:63], v[88:91], v[72:75], 0
    s_add_u32 m0, s41, 32768
    s_add_u32 s43, s40, 256
    buffer_load_dwordx4 v4, s[16:19], s43 offen lds
    s_add_u32 m0, s41, 33792
    s_add_u32 s43, s40, 7424
    buffer_load_dwordx4 v5, s[16:19], s43 offen lds
    ds_read_b128 v[88:91], v122 offset:0
    ds_read_b64_tr_b16 v[64:65], v124 offset:14336
    ds_read_b64_tr_b16 v[66:67], v124 offset:16128
    ds_read_b64_tr_b16 v[68:69], v124 offset:14392
    ds_read_b64_tr_b16 v[70:71], v124 offset:16184
    ds_read_b64_tr_b16 v[72:73], v124 offset:14448
    ds_read_b64_tr_b16 v[74:75], v124 offset:16240
    s_waitcnt lgkmcnt(7)
    v_mfma_f32_32x32x16_bf16 v[16:31], v[92:95], v[76:79], v[16:31]
    v_mfma_f32_32x32x16_bf16 v[32:47], v[92:95], v[80:83], v[32:47]
    v_mfma_f32_32x32x16_bf16 v[48:63], v[92:95], v[84:87], v[48:63]
    s_add_u32 s43, s42, 344064
    s_add_u32 m0, s45, 57344
    s_nop 0
    buffer_load_dwordx4 v136, s[20:23], s43 offen lds
    ds_read_b128 v[92:95], v123 offset:0
    ds_read_b64_tr_b16 v[76:77], v124 offset:21504
    ds_read_b64_tr_b16 v[78:79], v124 offset:23296
    ds_read_b64_tr_b16 v[80:81], v124 offset:21560
    ds_read_b64_tr_b16 v[82:83], v124 offset:23352
    ds_read_b64_tr_b16 v[84:85], v124 offset:21616
    ds_read_b64_tr_b16 v[86:87], v124 offset:23408
    s_waitcnt lgkmcnt(7)
    v_mfma_f32_32x32x16_bf16 v[16:31], v[88:91], v[64:67], v[16:31]
    v_mfma_f32_32x32x16_bf16 v[32:47], v[88:91], v[68:71], v[32:47]
    v_mfma_f32_32x32x16_bf16 v[48:63], v[88:91], v[72:75], v[48:63]
    s_add_u32 s43, s42, 344064
    s_add_u32 m0, s45, 65536
    s_nop 0
    buffer_load_dwordx4 v137, s[20:23], s43 offen lds
    s_add_u32 m0, s45, 73728
    s_nop 0
    buffer_load_dwordx4 v138, s[20:23], s43 offen lds
    s_waitcnt lgkmcnt(0)
    s_waitcnt vmcnt(5)
    s_barrier
    ds_read_b128 v[88:91], v120 offset:16384
    ds_read_b64_tr_b16 v[64:65], v125 offset:0
    ds_read_b64_tr_b16 v[66:67], v125 offset:1792
    ds_read_b64_tr_b16 v[68:69], v125 offset:56
    ds_read_b64_tr_b16 v[70:71], v125 offset:1848
    ds_read_b64_tr_b16 v[72:73], v125 offset:112
    ds_read_b64_tr_b16 v[74:75], v125 offset:1904
    v_mfma_f32_32x32x16_bf16 v[16:31], v[92:95], v[76:79], v[16:31]
    v_mfma_f32_32x32x16_bf16 v[32:47], v[92:95], v[80:83], v[32:47]
    v_mfma_f32_32x32x16_bf16 v[48:63], v[92:95], v[84:87], v[48:63]
    s_cmp_lt_u32 s38, 4
    s_cbranch_scc0 Lk1_d13
    s_add_u32 s43, s42, 344064
    s_add_u32 m0, s45, 81920
    s_nop 0
    buffer_load_dwordx4 v139, s[20:23], s43 offen lds
Lk1_d13:
    ds_read_b128 v[92:95], v121 offset:16384
    ds_read_b64_tr_b16 v[76:77], v125 offset:7168
    ds_read_b64_tr_b16 v[78:79], v125 offset:8960
    ds_read_b64_tr_b16 v[80:81], v125 offset:7224
    ds_read_b64_tr_b16 v[82:83], v125 offset:9016
    ds_read_b64_tr_b16 v[84:85], v125 offset:7280
    ds_read_b64_tr_b16 v[86:87], v125 offset:9072
    s_waitcnt lgkmcnt(7)
    v_mfma_f32_32x32x16_bf16 v[16:31], v[88:91], v[64:67], v[16:31]
    v_mfma_f32_32x32x16_bf16 v[32:47], v[88:91], v[68:71], v[32:47]
    v_mfma_f32_32x32x16_bf16 v[48:63], v[88:91], v[72:75], v[48:63]
    s_add_u32 m0, s41, 0
    s_add_u32 s43, s40, 384
    buffer_load_dwordx4 v4, s[16:19], s43 offen lds
    s_add_u32 m0, s41, 1024
    s_add_u32 s43, s40, 7552
    buffer_load_dwordx4 v5, s[16:19], s43 offen lds
    ds_read_b128 v[88:91], v122 offset:16384
    ds_read_b64_tr_b16 v[64:65], v125 offset:14336
    ds_read_b64_tr_b16 v[66:67], v125 offset:16128
    ds_read_b64_tr_b16 v[68:69], v125 offset:14392
    ds_read_b64_tr_b16 v[70:71], v125 offset:16184
    ds_read_b64_tr_b16 v[72:73], v125 offset:14448
    ds_read_b64_tr_b16 v[74:75], v125 offset:16240
    s_waitcnt lgkmcnt(7)
    v_mfma_f32_32x32x16_bf16 v[16:31], v[92:95], v[76:79], v[16:31]
    v_mfma_f32_32x32x16_bf16 v[32:47], v[92:95], v[80:83], v[32:47]
    v_mfma_f32_32x32x16_bf16 v[48:63], v[92:95], v[84:87], v[48:63]
    s_add_u32 s43, s42, 516096
    s_add_u32 m0, s45, 0
    s_nop 0
    buffer_load_dwordx4 v136, s[20:23], s43 offen lds
    ds_read_b128 v[92:95], v123 offset:16384
    ds_read_b64_tr_b16 v[76:77], v125 offset:21504
    ds_read_b64_tr_b16 v[78:79], v125 offset:23296
    ds_read_b64_tr_b16 v[80:81], v125 offset:21560
    ds_read_b64_tr_b16 v[82:83], v125 offset:23352
    ds_read_b64_tr_b16 v[84:85], v125 offset:21616
    ds_read_b64_tr_b16 v[86:87], v125 offset:23408
    s_waitcnt lgkmcnt(7)
    v_mfma_f32_32x32x16_bf16 v[16:31], v[88:91], v[64:67], v[16:31]
    v_mfma_f32_32x32x16_bf16 v[32:47], v[88:91], v[68:71], v[32:47]
    v_mfma_f32_32x32x16_bf16 v[48:63], v[88:91], v[72:75], v[48:63]
    s_add_u32 s43, s42, 516096
    s_add_u32 m0, s45, 8192
    s_nop 0
    buffer_load_dwordx4 v137, s[20:23], s43 offen lds
    s_add_u32 m0, s45, 16384
    s_nop 0
    buffer_load_dwordx4 v138, s[20:23], s43 offen lds
    s_waitcnt lgkmcnt(0)
    s_waitcnt vmcnt(5)
    s_barrier
    ds_read_b128 v[88:91], v120 offset:32768
    ds_read_b64_tr_b16 v[64:65], v126 offset:0
    ds_read_b64_tr_b16 v[66:67], v126 offset:1792
    ds_read_b64_tr_b16 v[68:69], v126 offset:56
    ds_read_b64_tr_b16 v[70:71], v126 offset:1848
    ds_read_b64_tr_b16 v[72:73], v126 offset:112
    ds_read_b64_tr_b16 v[74:75], v126 offset:1904
    v_mfma_f32_32x32x16_bf16 v[16:31], v[92:95], v[76:79], v[16:31]
    v_mfma_f32_32x32x16_bf16 v[32:47], v[92:95], v[80:83], v[32:47]
    v_mfma_f32_32x32x16_bf16 v[48:63], v[92:95], v[84:87], v[48:63]
    s_cmp_lt_u32 s38, 4
    s_cbranch_scc0 Lk1_d14
    s_add_u32 s43, s42, 516096
    s_add_u32 m0, s45, 24576
    s_nop 0
    buffer_load_dwordx4 v139, s[20:23], s43 offen lds
Lk1_d14:
    ds_read_b128 v[92:95], v121 offset:32768
    ds_read_b64_tr_b16 v[76:77], v126 offset:7168
    ds_read_b64_tr_b16 v[78:79], v126 offset:8960
    ds_read_b64_tr_b16 v[80:81], v126 offset:7224
    ds_read_b64_tr_b16 v[82:83], v126 offset:9016
    ds_read_b64_tr_b16 v[84:85], v126 offset:7280
    ds_read_b64_tr_b16 v[86:87], v126 offset:9072
    s_waitcnt lgkmcnt(7)
    v_mfma_f32_32x32x16_bf16 v[16:31], v[88:91], v[64:67], v[16:31]
    v_mfma_f32_32x32x16_bf16 v[32:47], v[88:91], v[68:71], v[32:47]
    v_mfma_f32_32x32x16_bf16 v[48:63], v[88:91], v[72:75], v[48:63]
    s_add_u32 m0, s41, 16384
    s_add_u32 s43, s40, 512
    buffer_load_dwordx4 v4, s[16:19], s43 offen lds
    s_add_u32 m0, s41, 17408
    s_add_u32 s43, s40, 7680
    buffer_load_dwordx4 v5, s[16:19], s43 offen lds
    ds_read_b128 v[88:91], v122 offset:32768
    ds_read_b64_tr_b16 v[64:65], v126 offset:14336
    ds_read_b64_tr_b16 v[66:67], v126 offset:16128
    ds_read_b64_tr_b16 v[68:69], v126 offset:14392
    ds_read_b64_tr_b16 v[70:71], v126 offset:16184
    ds_read_b64_tr_b16 v[72:73], v126 offset:14448
    ds_read_b64_tr_b16 v[74:75], v126 offset:16240
    s_waitcnt lgkmcnt(7)
    v_mfma_f32_32x32x16_bf16 v[16:31], v[92:95], v[76:79], v[16:31]
    v_mfma_f32_32x32x16_bf16 v[32:47], v[92:95], v[80:83], v[32:47]
    v_mfma_f32_32x32x16_bf16 v[48:63], v[92:95], v[84:87], v[48:63]
    s_add_u32 s43, s42, 688128
    s_add_u32 m0, s45, 28672
    s_nop 0
    buffer_load_dwordx4 v136, s[20:23], s43 offen lds
    ds_read_b128 v[92:95], v123 offset:32768
    ds_read_b64_tr_b16 v[76:77], v126 offset:21504
    ds_read_b64_tr_b16 v[78:79], v126 offset:23296
    ds_read_b64_tr_b16 v[80:81], v126 offset:21560
    ds_read_b64_tr_b16 v[82:83], v126 offset:23352
    ds_read_b64_tr_b16 v[84:85], v126 offset:21616
    ds_read_b64_tr_b16 v[86:87], v126 offset:23408
    s_waitcnt lgkmcnt(7)
    v_mfma_f32_32x32x16_bf16 v[16:31], v[88:91], v[64:67], v[16:31]
    v_mfma_f32_32x32x16_bf16 v[32:47], v[88:91], v[68:71], v[32:47]
    v_mfma_f32_32x32x16_bf16 v[48:63], v[88:91], v[72:75], v[48:63]
    s_add_u32 s43, s42, 688128
    s_add_u32 m0, s45, 36864
    s_nop 0
    buffer_load_dwordx4 v137, s[20:23], s43 offen lds
    s_add_u32 m0, s45, 45056
    s_nop 0
    buffer_load_dwordx4 v138, s[20:23], s43 offen lds
    s_waitcnt lgkmcnt(0)
    s_waitcnt vmcnt(5)
    s_barrier
    ds_read_b128 v[88:91], v120 offset:0
    ds_read_b64_tr_b16 v[64:65], v124 offset:0
    ds_read_b64_tr_b16 v[66:67], v124 offset:1792
    ds_read_b64_tr_b16 v[68:69], v124 offset:56
    ds_read_b64_tr_b16 v[70:71], v124 offset:1848
    ds_read_b64_tr_b16 v[72:73], v124 offset:112
    ds_read_b64_tr_b16 v[74:75], v124 offset:1904
    v_mfma_f32_32x32x16_bf16 v[16:31], v[92:95], v[76:79], v[16:31]
    v_mfma_f32_32x32x16_bf16 v[32:47], v[92:95], v[80:83], v[32:47]
    v_mfma_f32_32x32x16_bf16 v[48:63], v[92:95], v[84:87], v[48:63]
    s_cmp_lt_u32 s38, 4
    s_cbranch_scc0 Lk1_d15
    s_add_u32 s43, s42, 688128
    s_add_u32 m0, s45, 53248
    s_nop 0
    buffer_load_dwordx4 v139, s[20:23], s43 offen lds
Lk1_d15:
    ds_read_b128 v[92:95], v121 offset:0
    ds_read_b64_tr_b16 v[76:77], v124 offset:7168
    ds_read_b64_tr_b16 v[78:79], v124 offset:8960
    ds_read_b64_tr_b16 v[80:81], v124 offset:7224
    ds_read_b64_tr_b16 v[82:83], v124 offset:9016
    ds_read_b64_tr_b16 v[84:85], v124 offset:7280
    ds_read_b64_tr_b16 v[86:87], v124 offset:9072
    s_waitcnt lgkmcnt(7)
    v_mfma_f32_32x32x16_bf16 v[16:31], v[88:91], v[64:67], v[16:31]
    v_mfma_f32_32x32x16_bf16 v[32:47], v[88:91], v[68:71], v[32:47]
    v_mfma_f32_32x32x16_bf16 v[48:63], v[88:91], v[72:75], v[48:63]
    s_add_u32 m0, s41, 32768
    s_add_u32 s43, s40, 640
    buffer_load_dwordx4 v4, s[16:19], s43 offen lds
    s_add_u32 m0, s41, 33792
    s_add_u32 s43, s40, 7808
    buffer_load_dwordx4 v5, s[16:19], s43 offen lds
    ds_read_b128 v[88:91], v122 offset:0
    ds_read_b64_tr_b16 v[64:65], v124 offset:14336
    ds_read_b64_tr_b16 v[66:67], v124 offset:16128
    ds_read_b64_tr_b16 v[68:69], v124 offset:14392
    ds_read_b64_tr_b16 v[70:71], v124 offset:16184
    ds_read_b64_tr_b16 v[72:73], v124 offset:14448
    ds_read_b64_tr_b16 v[74:75], v124 offset:16240
    s_waitcnt lgkmcnt(7)
    v_mfma_f32_32x32x16_bf16 v[16:31], v[92:95], v[76:79], v[16:31]
    v_mfma_f32_32x32x16_bf16 v[32:47], v[92:95], v[80:83], v[32:47]
    v_mfma_f32_32x32x16_bf16 v[48:63], v[92:95], v[84:87], v[48:63]
    s_add_u32 s43, s42, 860160
    s_add_u32 m0, s45, 57344
    s_nop 0
    buffer_load_dwordx4 v136, s[20:23], s43 offen lds
    ds_read_b128 v[92:95], v123 offset:0
    ds_read_b64_tr_b16 v[76:77], v124 offset:21504
    ds_read_b64_tr_b16 v[78:79], v124 offset:23296
    ds_read_b64_tr_b16 v[80:81], v124 offset:21560
    ds_read_b64_tr_b16 v[82:83], v124 offset:23352
    ds_read_b64_tr_b16 v[84:85], v124 offset:21616
    ds_read_b64_tr_b16 v[86:87], v124 offset:23408
    s_waitcnt lgkmcnt(7)
    v_mfma_f32_32x32x16_bf16 v[16:31], v[88:91], v[64:67], v[16:31]
    v_mfma_f32_32x32x16_bf16 v[32:47], v[88:91], v[68:71], v[32:47]
    v_mfma_f32_32x32x16_bf16 v[48:63], v[88:91], v[72:75], v[48:63]
    s_add_u32 s43, s42, 860160
    s_add_u32 m0, s45, 65536
    s_nop 0
    buffer_load_dwordx4 v137, s[20:23], s43 offen lds
    s_add_u32 m0, s45, 73728
    s_nop 0
    buffer_load_dwordx4 v138, s[20:23], s43 offen lds
    s_waitcnt lgkmcnt(0)
    s_waitcnt vmcnt(5)
    s_barrier
    ds_read_b128 v[88:91], v120 offset:16384
    ds_read_b64_tr_b16 v[64:65], v125 offset:0
    ds_read_b64_tr_b16 v[66:67], v125 offset:1792
    ds_read_b64_tr_b16 v[68:69], v125 offset:56
    ds_read_b64_tr_b16 v[70:71], v125 offset:1848
    ds_read_b64_tr_b16 v[72:73], v125 offset:112
    ds_read_b64_tr_b16 v[74:75], v125 offset:1904
    v_mfma_f32_32x32x16_bf16 v[16:31], v[92:95], v[76:79], v[16:31]
    v_mfma_f32_32x32x16_bf16 v[32:47], v[92:95], v[80:83], v[32:47]
    v_mfma_f32_32x32x16_bf16 v[48:63], v[92:95], v[84:87], v[48:63]
    s_cmp_lt_u32 s38, 4
    s_cbranch_scc0 Lk1_d16
    s_add_u32 s43, s42, 860160
    s_add_u32 m0, s45, 81920
    s_nop 0
    buffer_load_dwordx4 v139, s[20:23], s43 offen lds
Lk1_d16:
    ds_read_b128 v[92:95], v121 offset:16384
    ds_read_b64_tr_b16 v[76:77], v125 offset:7168
    ds_read_b64_tr_b16 v[78:79], v125 offset:8960
    ds_read_b64_tr_b16 v[80:81], v125 offset:7224
    ds_read_b64_tr_b16 v[82:83], v125 offset:9016
    ds_read_b64_tr_b16 v[84:85], v125 offset:7280
    ds_read_b64_tr_b16 v[86:87], v125 offset:9072
    s_waitcnt lgkmcnt(7)
    v_mfma_f32_32x32x16_bf16 v[16:31], v[88:91], v[64:67], v[16:31]
    v_mfma_f32_32x32x16_bf16 v[32:47], v[88:91], v[68:71], v[32:47]
    v_mfma_f32_32x32x16_bf16 v[48:63], v[88:91], v[72:75], v[48:63]
    s_add_u32 m0, s41, 0
    s_add_u32 s43, s40, 768
    buffer_load_dwordx4 v4, s[16:19], s43 offen lds
    s_add_u32 m0, s41, 1024
    s_add_u32 s43, s40, 7936
    buffer_load_dwordx4 v5, s[16:19], s43 offen lds
    ds_read_b128 v[88:91], v122 offset:16384
    ds_read_b64_tr_b16 v[64:65], v125 offset:14336
    ds_read_b64_tr_b16 v[66:67], v125 offset:16128
    ds_read_b64_tr_b16 v[68:69], v125 offset:14392
    ds_read_b64_tr_b16 v[70:71], v125 offset:16184
    ds_read_b64_tr_b16 v[72:73], v125 offset:14448
    ds_read_b64_tr_b16 v[74:75], v125 offset:16240
    s_waitcnt lgkmcnt(7)
    v_mfma_f32_32x32x16_bf16 v[16:31], v[92:95], v[76:79], v[16:31]
    v_mfma_f32_32x32x16_bf16 v[32:47], v[92:95], v[80:83], v[32:47]
    v_mfma_f32_32x32x16_bf16 v[48:63], v[92:95], v[84:87], v[48:63]
    s_add_u32 s43, s42, 1032192
    s_add_u32 m0, s45, 0
    s_nop 0
    buffer_load_dwordx4 v136, s[20:23], s43 offen lds
    ds_read_b128 v[92:95], v123 offset:16384
    ds_read_b64_tr_b16 v[76:77], v125 offset:21504
    ds_read_b64_tr_b16 v[78:79], v125 offset:23296
    ds_read_b64_tr_b16 v[80:81], v125 offset:21560
    ds_read_b64_tr_b16 v[82:83], v125 offset:23352
    ds_read_b64_tr_b16 v[84:85], v125 offset:21616
    ds_read_b64_tr_b16 v[86:87], v125 offset:23408
    s_waitcnt lgkmcnt(7)
    v_mfma_f32_32x32x16_bf16 v[16:31], v[88:91], v[64:67], v[16:31]
    v_mfma_f32_32x32x16_bf16 v[32:47], v[88:91], v[68:71], v[32:47]
    v_mfma_f32_32x32x16_bf16 v[48:63], v[88:91], v[72:75], v[48:63]
    s_add_u32 s43, s42, 1032192
    s_add_u32 m0, s45, 8192
    s_nop 0
    buffer_load_dwordx4 v137, s[20:23], s43 offen lds
    s_add_u32 m0, s45, 16384
    s_nop 0
    buffer_load_dwordx4 v138, s[20:23], s43 offen lds
    s_waitcnt lgkmcnt(0)
    s_waitcnt vmcnt(5)
    s_barrier
    ds_read_b128 v[88:91], v120 offset:32768
    ds_read_b64_tr_b16 v[64:65], v126 offset:0
    ds_read_b64_tr_b16 v[66:67], v126 offset:1792
    ds_read_b64_tr_b16 v[68:69], v126 offset:56
    ds_read_b64_tr_b16 v[70:71], v126 offset:1848
    ds_read_b64_tr_b16 v[72:73], v126 offset:112
    ds_read_b64_tr_b16 v[74:75], v126 offset:1904
    v_mfma_f32_32x32x16_bf16 v[16:31], v[92:95], v[76:79], v[16:31]
    v_mfma_f32_32x32x16_bf16 v[32:47], v[92:95], v[80:83], v[32:47]
    v_mfma_f32_32x32x16_bf16 v[48:63], v[92:95], v[84:87], v[48:63]
    s_cmp_lt_u32 s38, 4
    s_cbranch_scc0 Lk1_d17
    s_add_u32 s43, s42, 1032192
    s_add_u32 m0, s45, 24576
    s_nop 0
    buffer_load_dwordx4 v139, s[20:23], s43 offen lds
Lk1_d17:
    ds_read_b128 v[92:95], v121 offset:32768
    ds_read_b64_tr_b16 v[76:77], v126 offset:7168
    ds_read_b64_tr_b16 v[78:79], v126 offset:8960
    ds_read_b64_tr_b16 v[80:81], v126 offset:7224
    ds_read_b64_tr_b16 v[82:83], v126 offset:9016
    ds_read_b64_tr_b16 v[84:85], v126 offset:7280
    ds_read_b64_tr_b16 v[86:87], v126 offset:9072
    s_waitcnt lgkmcnt(7)
    v_mfma_f32_32x32x16_bf16 v[16:31], v[88:91], v[64:67], v[16:31]
    v_mfma_f32_32x32x16_bf16 v[32:47], v[88:91], v[68:71], v[32:47]
    v_mfma_f32_32x32x16_bf16 v[48:63], v[88:91], v[72:75], v[48:63]
    ds_read_b128 v[88:91], v122 offset:32768
    ds_read_b64_tr_b16 v[64:65], v126 offset:14336
    ds_read_b64_tr_b16 v[66:67], v126 offset:16128
    ds_read_b64_tr_b16 v[68:69], v126 offset:14392
    ds_read_b64_tr_b16 v[70:71], v126 offset:16184
    ds_read_b64_tr_b16 v[72:73], v126 offset:14448
    ds_read_b64_tr_b16 v[74:75], v126 offset:16240
    s_waitcnt lgkmcnt(7)
    v_mfma_f32_32x32x16_bf16 v[16:31], v[92:95], v[76:79], v[16:31]
    v_mfma_f32_32x32x16_bf16 v[32:47], v[92:95], v[80:83], v[32:47]
    v_mfma_f32_32x32x16_bf16 v[48:63], v[92:95], v[84:87], v[48:63]
    ds_read_b128 v[92:95], v123 offset:32768
    ds_read_b64_tr_b16 v[76:77], v126 offset:21504
    ds_read_b64_tr_b16 v[78:79], v126 offset:23296
    ds_read_b64_tr_b16 v[80:81], v126 offset:21560
    ds_read_b64_tr_b16 v[82:83], v126 offset:23352
    ds_read_b64_tr_b16 v[84:85], v126 offset:21616
    ds_read_b64_tr_b16 v[86:87], v126 offset:23408
    s_waitcnt lgkmcnt(7)
    v_mfma_f32_32x32x16_bf16 v[16:31], v[88:91], v[64:67], v[16:31]
    v_mfma_f32_32x32x16_bf16 v[32:47], v[88:91], v[68:71], v[32:47]
    v_mfma_f32_32x32x16_bf16 v[48:63], v[88:91], v[72:75], v[48:63]
    s_waitcnt lgkmcnt(0)
    s_waitcnt vmcnt(0)
    s_barrier
    ds_read_b128 v[88:91], v120 offset:0
    ds_read_b64_tr_b16 v[64:65], v124 offset:0
    ds_read_b64_tr_b16 v[66:67], v124 offset:1792
    ds_read_b64_tr_b16 v[68:69], v124 offset:56
    ds_read_b64_tr_b16 v[70:71], v124 offset:1848
    ds_read_b64_tr_b16 v[72:73], v124 offset:112
    ds_read_b64_tr_b16 v[74:75], v124 offset:1904
    v_mfma_f32_32x32x16_bf16 v[16:31], v[92:95], v[76:79], v[16:31]
    v_mfma_f32_32x32x16_bf16 v[32:47], v[92:95], v[80:83], v[32:47]
    v_mfma_f32_32x32x16_bf16 v[48:63], v[92:95], v[84:87], v[48:63]
    ds_read_b128 v[92:95], v121 offset:0
    ds_read_b64_tr_b16 v[76:77], v124 offset:7168
    ds_read_b64_tr_b16 v[78:79], v124 offset:8960
    ds_read_b64_tr_b16 v[80:81], v124 offset:7224
    ds_read_b64_tr_b16 v[82:83], v124 offset:9016
    ds_read_b64_tr_b16 v[84:85], v124 offset:7280
    ds_read_b64_tr_b16 v[86:87], v124 offset:9072
    s_waitcnt lgkmcnt(7)
    v_mfma_f32_32x32x16_bf16 v[16:31], v[88:91], v[64:67], v[16:31]
    v_mfma_f32_32x32x16_bf16 v[32:47], v[88:91], v[68:71], v[32:47]
    v_mfma_f32_32x32x16_bf16 v[48:63], v[88:91], v[72:75], v[48:63]
    ds_read_b128 v[88:91], v122 offset:0
    ds_read_b64_tr_b16 v[64:65], v124 offset:14336
    ds_read_b64_tr_b16 v[66:67], v124 offset:16128
    ds_read_b64_tr_b16 v[68:69], v124 offset:14392
    ds_read_b64_tr_b16 v[70:71], v124 offset:16184
    ds_read_b64_tr_b16 v[72:73], v124 offset:14448
    ds_read_b64_tr_b16 v[74:75], v124 offset:16240
    s_waitcnt lgkmcnt(7)
    v_mfma_f32_32x32x16_bf16 v[16:31], v[92:95], v[76:79], v[16:31]
    v_mfma_f32_32x32x16_bf16 v[32:47], v[92:95], v[80:83], v[32:47]
    v_mfma_f32_32x32x16_bf16 v[48:63], v[92:95], v[84:87], v[48:63]
    ds_read_b128 v[92:95], v123 offset:0
    ds_read_b64_tr_b16 v[76:77], v124 offset:21504
    ds_read_b64_tr_b16 v[78:79], v124 offset:23296
    ds_read_b64_tr_b16 v[80:81], v124 offset:21560
    ds_read_b64_tr_b16 v[82:83], v124 offset:23352
    ds_read_b64_tr_b16 v[84:85], v124 offset:21616
    ds_read_b64_tr_b16 v[86:87], v124 offset:23408
    s_waitcnt lgkmcnt(7)
    v_mfma_f32_32x32x16_bf16 v[16:31], v[88:91], v[64:67], v[16:31]
    v_mfma_f32_32x32x16_bf16 v[32:47], v[88:91], v[68:71], v[32:47]
    v_mfma_f32_32x32x16_bf16 v[48:63], v[88:91], v[72:75], v[48:63]
    s_waitcnt lgkmcnt(0)
    v_mfma_f32_32x32x16_bf16 v[16:31], v[92:95], v[76:79], v[16:31]
    v_mfma_f32_32x32x16_bf16 v[32:47], v[92:95], v[80:83], v[32:47]
    v_mfma_f32_32x32x16_bf16 v[48:63], v[92:95], v[84:87], v[48:63]
    s_nop 15
    s_add_u32 s43, s58, 0
    s_lshr_b32 s44, s43, 4
    s_and_b32 s43, s43, 15
    s_lshl_b32 s46, s36, 4
    s_add_u32 s43, s43, s46
    s_lshl_b32 s43, s43, 6
    s_add_u32 s43, s43, s39
    s_lshl_b32 s43, s43, 11
    s_lshl_b32 s46, s44, 22
    s_add_u32 s43, s43, s46
    v_cvt_pk_bf16_f32 v96, v16, v17
    v_cvt_pk_bf16_f32 v97, v18, v19
    v_cvt_pk_bf16_f32 v98, v20, v21
    v_cvt_pk_bf16_f32 v99, v22, v23
    v_cvt_pk_bf16_f32 v100, v24, v25
    v_cvt_pk_bf16_f32 v101, v26, v27
    v_cvt_pk_bf16_f32 v102, v28, v29
    v_cvt_pk_bf16_f32 v103, v30, v31
    v_cndmask_b32 v96, v9, v96, s[50:51]
    v_cndmask_b32 v97, v9, v97, s[50:51]
    v_cndmask_b32 v98, v9, v98, s[50:51]
    v_cndmask_b32 v99, v9, v99, s[50:51]
    v_cndmask_b32 v100, v9, v100, s[50:51]
    v_cndmask_b32 v101, v9, v101, s[50:51]
    v_cndmask_b32 v102, v9, v102, s[50:51]
    v_cndmask_b32 v103, v9, v103, s[50:51]
    buffer_store_dwordx4 v[96:99], v12, s[24:27], s43 offen sc0 sc1
    buffer_store_dwordx4 v[100:103], v12, s[24:27], s43 offen offset:1024 sc0 sc1
    s_add_u32 s43, s58, 1
    s_lshr_b32 s44, s43, 4
    s_and_b32 s43, s43, 15
    s_lshl_b32 s46, s36, 4
    s_add_u32 s43, s43, s46
    s_lshl_b32 s43, s43, 6
    s_add_u32 s43, s43, s39
    s_lshl_b32 s43, s43, 11
    s_lshl_b32 s46, s44, 22
    s_add_u32 s43, s43, s46
    v_cvt_pk_bf16_f32 v104, v32, v33
    v_cvt_pk_bf16_f32 v105, v34, v35
    v_cvt_pk_bf16_f32 v106, v36, v37
    v_cvt_pk_bf16_f32 v107, v38, v39
    v_cvt_pk_bf16_f32 v108, v40, v41
    v_cvt_pk_bf16_f32 v109, v42, v43
    v_cvt_pk_bf16_f32 v110, v44, v45
    v_cvt_pk_bf16_f32 v111, v46, v47
    v_cndmask_b32 v104, v9, v104, s[50:51]
    v_cndmask_b32 v105, v9, v105, s[50:51]
    v_cndmask_b32 v106, v9, v106, s[50:51]
    v_cndmask_b32 v107, v9, v107, s[50:51]
    v_cndmask_b32 v108, v9, v108, s[50:51]
    v_cndmask_b32 v109, v9, v109, s[50:51]
    v_cndmask_b32 v110, v9, v110, s[50:51]
    v_cndmask_b32 v111, v9, v111, s[50:51]
    buffer_store_dwordx4 v[104:107], v12, s[24:27], s43 offen sc0 sc1
    buffer_store_dwordx4 v[108:111], v12, s[24:27], s43 offen offset:1024 sc0 sc1
    s_add_u32 s43, s58, 2
    s_lshr_b32 s44, s43, 4
    s_and_b32 s43, s43, 15
    s_lshl_b32 s46, s36, 4
    s_add_u32 s43, s43, s46
    s_lshl_b32 s43, s43, 6
    s_add_u32 s43, s43, s39
    s_lshl_b32 s43, s43, 11
    s_lshl_b32 s46, s44, 22
    s_add_u32 s43, s43, s46
    v_cvt_pk_bf16_f32 v112, v48, v49
    v_cvt_pk_bf16_f32 v113, v50, v51
    v_cvt_pk_bf16_f32 v114, v52, v53
    v_cvt_pk_bf16_f32 v115, v54, v55
    v_cvt_pk_bf16_f32 v116, v56, v57
    v_cvt_pk_bf16_f32 v117, v58, v59
    v_cvt_pk_bf16_f32 v118, v60, v61
    v_cvt_pk_bf16_f32 v119, v62, v63
    v_cndmask_b32 v112, v9, v112, s[50:51]
    v_cndmask_b32 v113, v9, v113, s[50:51]
    v_cndmask_b32 v114, v9, v114, s[50:51]
    v_cndmask_b32 v115, v9, v115, s[50:51]
    v_cndmask_b32 v116, v9, v116, s[50:51]
    v_cndmask_b32 v117, v9, v117, s[50:51]
    v_cndmask_b32 v118, v9, v118, s[50:51]
    v_cndmask_b32 v119, v9, v119, s[50:51]
    buffer_store_dwordx4 v[112:115], v12, s[24:27], s43 offen sc0 sc1
    buffer_store_dwordx4 v[116:119], v12, s[24:27], s43 offen offset:1024 sc0 sc1
Lk1_fin:
Lk1_end:
    s_endpgm
.globl attn_kernel
.p2align 8
.type attn_kernel,@function
attn_kernel:
    s_cmp_ge_u32 s2, 256
    s_cbranch_scc1 Lk2_end
    s_load_dwordx2 s[12:13], s[0:1], 72
    s_load_dwordx2 s[4:5], s[0:1], 16
    s_load_dwordx2 s[6:7], s[0:1], 40
    s_and_b32 s32, s2, 7
    s_lshr_b32 s33, s2, 3
    s_lshl_b32 s32, s32, 1
    s_and_b32 s37, s33, 1
    s_add_u32 s32, s32, s37
    s_lshr_b32 s33, s33, 1
    v_lshrrev_b32 v3, 6, v0
    v_and_b32 v2, 63, v0
    v_readfirstlane_b32 s34, v3
    v_lshlrev_b32 v1, 4, v2
    s_mov_b32 s70, 0
    s_and_b32 s37, s34, 3
    s_lshl_b32 s35, s33, 2
    s_add_u32 s35, s35, s37
    s_lshr_b32 s36, s34, 2
    s_mul_i32 s37, s36, 8192
    v_add_u32 v120, s37, v1
    v_add_u32 v121, 65536, v120
    s_waitcnt lgkmcnt(0)
    s_mov_b32 s16, s12
    s_and_b32 s17, s13, 0xffff
    s_mov_b32 s18, 16785408
    s_mov_b32 s19, 0x00020000
    s_lshl_b32 s64, s2, 3
    s_add_u32 s64, s64, s34
    s_cmp_lt_u32 s64, 392
    s_cselect_b32 s4, s4, s6
    s_cselect_b32 s5, s5, s7
    s_sub_u32 s65, s64, 392
    s_cselect_b32 s64, s64, s65
    s_lshl_b32 s64, s64, 10
    s_mov_b32 s20, s4
    s_and_b32 s21, s5, 0xffff
    s_mov_b32 s22, 401408
    s_mov_b32 s23, 0x00020000
    s_add_u32 s37, s32, 16
    s_lshl_b32 s38, s37, 6
    s_add_u32 s38, s38, s35
    s_lshl_b32 s38, s38, 11
    buffer_load_dwordx4 v[16:19], v1, s[16:19], s38 offen
    buffer_load_dwordx4 v[20:23], v1, s[16:19], s38 offen offset:1024
    s_lshl_b32 s40, s37, 17
    s_lshl_b32 s41, s34, 10
    s_add_u32 s40, s40, s41
    s_add_u32 s42, s40, 8388608
    s_add_u32 s40, s40, 4194304
    s_mov_b32 s48, 0xffffffff
    s_mov_b32 s49, 0
    s_add_u32 s43, s40, 0
    s_add_u32 m0, s41, 0
    s_add_u32 s44, s42, 0
    buffer_load_dwordx4 v1, s[16:19], s43 offen lds
    s_add_u32 m0, s41, 65536
    s_nop 0
    buffer_load_dwordx4 v1, s[16:19], s44 offen lds
    s_add_u32 s43, s40, 8192
    s_add_u32 m0, s41, 8192
    s_add_u32 s44, s42, 8192
    buffer_load_dwordx4 v1, s[16:19], s43 offen lds
    s_add_u32 m0, s41, 73728
    s_nop 0
    buffer_load_dwordx4 v1, s[16:19], s44 offen lds
    s_add_u32 s43, s40, 16384
    s_add_u32 m0, s41, 16384
    s_add_u32 s44, s42, 16384
    buffer_load_dwordx4 v1, s[16:19], s43 offen lds
    s_add_u32 m0, s41, 81920
    s_nop 0
    buffer_load_dwordx4 v1, s[16:19], s44 offen lds
    s_add_u32 s43, s40, 24576
    s_add_u32 m0, s41, 24576
    s_add_u32 s44, s42, 24576
    buffer_load_dwordx4 v1, s[16:19], s43 offen lds
    s_add_u32 m0, s41, 90112
    s_nop 0
    buffer_load_dwordx4 v1, s[16:19], s44 offen lds
    s_waitcnt vmcnt(4)
    s_barrier
    ds_read_b128 v[24:27], v1
    ds_read_b128 v[28:31], v1 offset:1024
    s_waitcnt lgkmcnt(0)
    v_mfma_f32_32x32x16_bf16 v[48:63], v[24:27], v[16:19], 0
    v_mfma_f32_32x32x16_bf16 v[48:63], v[28:31], v[20:23], v[48:63]
    s_add_u32 s43, s40, 32768
    s_add_u32 m0, s41, 32768
    s_add_u32 s44, s42, 32768
    buffer_load_dwordx4 v1, s[16:19], s43 offen lds
    s_add_u32 m0, s41, 98304
    s_nop 0
    buffer_load_dwordx4 v1, s[16:19], s44 offen lds
    s_add_u32 s43, s40, 40960
    s_add_u32 m0, s41, 40960
    s_add_u32 s44, s42, 40960
    buffer_load_dwordx4 v1, s[16:19], s43 offen lds
    s_add_u32 m0, s41, 106496
    s_nop 0
    buffer_load_dwordx4 v1, s[16:19], s44 offen lds
    v_mov_b32 v80, 0
    v_mov_b32 v81, 0
    v_mov_b32 v82, 0
    v_mov_b32 v83, 0
    v_mov_b32 v84, 0
    v_mov_b32 v85, 0
    v_mov_b32 v86, 0
    v_mov_b32 v87, 0
    v_mov_b32 v88, 0
    v_mov_b32 v89, 0
    v_mov_b32 v90, 0
    v_mov_b32 v91, 0
    v_mov_b32 v92, 0
    v_mov_b32 v93, 0
    v_mov_b32 v94, 0
    v_mov_b32 v95, 0
    v_max3_f32 v3, v48, v49, v50
    v_max3_f32 v3, v3, v51, v52
    v_max3_f32 v3, v3, v53, v54
    v_max3_f32 v3, v3, v55, v56
    v_max3_f32 v3, v3, v57, v58
    v_max3_f32 v3, v3, v59, v60
    v_max3_f32 v3, v3, v61, v62
    v_max_f32 v3, v3, v63
    v_mov_b32 v4, v3
    s_nop 1
    v_permlane32_swap_b32 v3, v4
    v_max_f32 v3, v3, v4
Lk2_setci:
    v_sub_f32 v96, 0, v3
    v_sub_f32 v97, 0, v3
    v_sub_f32 v98, 0, v3
    v_sub_f32 v99, 0, v3
    v_sub_f32 v100, 0, v3
    v_sub_f32 v101, 0, v3
    v_sub_f32 v102, 0, v3
    v_sub_f32 v103, 0, v3
    v_sub_f32 v104, 0, v3
    v_sub_f32 v105, 0, v3
    v_sub_f32 v106, 0, v3
    v_sub_f32 v107, 0, v3
    v_sub_f32 v108, 0, v3
    v_sub_f32 v109, 0, v3
    v_sub_f32 v110, 0, v3
    v_sub_f32 v111, 0, v3
    ds_read_b128 v[24:27], v120 offset:0
    ds_read_b128 v[28:31], v120 offset:1024
    s_waitcnt lgkmcnt(0)
    v_mfma_f32_32x32x16_bf16 v[48:63], v[24:27], v[16:19], v[96:111]
    v_mfma_f32_32x32x16_bf16 v[48:63], v[28:31], v[20:23], v[48:63]
    ds_read_b128 v[24:27], v120 offset:2048
    ds_read_b128 v[28:31], v120 offset:3072
    s_nop 9
    s_waitcnt lgkmcnt(0)
    v_mfma_f32_32x32x16_bf16 v[64:79], v[24:27], v[16:19], v[96:111]
    v_exp_f32 v48, v48
    v_exp_f32 v49, v49
    v_exp_f32 v50, v50
    v_exp_f32 v51, v51
    v_cvt_pk_bf16_f32 v40, v48, v49
    v_mfma_f32_32x32x16_bf16 v[64:79], v[28:31], v[20:23], v[64:79]
    ds_read_b128 v[24:27], v120 offset:4096
    ds_read_b128 v[28:31], v120 offset:5120
    v_exp_f32 v52, v52
    v_exp_f32 v53, v53
    v_cvt_pk_bf16_f32 v41, v50, v51
    v_exp_f32 v54, v54
    v_exp_f32 v55, v55
    v_cvt_pk_bf16_f32 v42, v52, v53
    v_exp_f32 v56, v56
    v_exp_f32 v57, v57
    v_cvt_pk_bf16_f32 v43, v54, v55
    v_exp_f32 v58, v58
    v_exp_f32 v59, v59
    v_cvt_pk_bf16_f32 v44, v56, v57
    ds_read_b128 v[32:35], v121 offset:0
    ds_read_b128 v[36:39], v121 offset:1024
    v_exp_f32 v60, v60
    v_exp_f32 v61, v61
    v_cvt_pk_bf16_f32 v45, v58, v59
    v_exp_f32 v62, v62
    v_exp_f32 v63, v63
    v_cvt_pk_bf16_f32 v46, v60, v61
    s_nop 0
    v_cvt_pk_bf16_f32 v47, v62, v63
    s_waitcnt lgkmcnt(2)
    v_mfma_f32_32x32x16_bf16 v[48:63], v[24:27], v[16:19], v[96:111]
    v_exp_f32 v64, v64
    v_exp_f32 v65, v65
    v_exp_f32 v66, v66
    v_exp_f32 v67, v67
    v_cvt_pk_bf16_f32 v112, v64, v65
    v_mfma_f32_32x32x16_bf16 v[48:63], v[28:31], v[20:23], v[48:63]
    ds_read_b128 v[24:27], v120 offset:6144
    ds_read_b128 v[28:31], v120 offset:7168
    v_exp_f32 v68, v68
    v_exp_f32 v69, v69
    v_cvt_pk_bf16_f32 v113, v66, v67
    v_exp_f32 v70, v70
    v_exp_f32 v71, v71
    v_cvt_pk_bf16_f32 v114, v68, v69
    s_waitcnt lgkmcnt(2)
    v_mfma_f32_32x32x16_bf16 v[80:95], v[32:35], v[40:43], v[80:95]
    v_exp_f32 v72, v72
    v_exp_f32 v73, v73
    v_cvt_pk_bf16_f32 v115, v70, v71
    v_exp_f32 v74, v74
    v_exp_f32 v75, v75
    v_cvt_pk_bf16_f32 v116, v72, v73
    v_mfma_f32_32x32x16_bf16 v[80:95], v[36:39], v[44:47], v[80:95]
    ds_read_b128 v[32:35], v121 offset:2048
    ds_read_b128 v[36:39], v121 offset:3072
    v_exp_f32 v76, v76
    v_exp_f32 v77, v77
    v_cvt_pk_bf16_f32 v117, v74, v75
    v_exp_f32 v78, v78
    v_exp_f32 v79, v79
    v_cvt_pk_bf16_f32 v118, v76, v77
    s_nop 0
    v_cvt_pk_bf16_f32 v119, v78, v79
    s_waitcnt vmcnt(4)
    s_barrier
    s_waitcnt lgkmcnt(2)
    v_mfma_f32_32x32x16_bf16 v[64:79], v[24:27], v[16:19], v[96:111]
    v_exp_f32 v48, v48
    v_exp_f32 v49, v49
    v_exp_f32 v50, v50
    v_exp_f32 v51, v51
    v_cvt_pk_bf16_f32 v40, v48, v49
    v_mfma_f32_32x32x16_bf16 v[64:79], v[28:31], v[20:23], v[64:79]
    ds_read_b128 v[24:27], v120 offset:16384
    ds_read_b128 v[28:31], v120 offset:17408
    v_exp_f32 v52, v52
    v_exp_f32 v53, v53
    v_cvt_pk_bf16_f32 v41, v50, v51
    v_exp_f32 v54, v54
    v_exp_f32 v55, v55
    v_cvt_pk_bf16_f32 v42, v52, v53
    s_add_u32 s43, s40, 49152
    s_add_u32 m0, s41, 49152
    s_add_u32 s44, s42, 49152
    buffer_load_dwordx4 v1, s[16:19], s43 offen lds
    s_add_u32 m0, s41, 114688
    s_nop 0
    buffer_load_dwordx4 v1, s[16:19], s44 offen lds
    s_waitcnt lgkmcnt(2)
    v_mfma_f32_32x32x16_bf16 v[80:95], v[32:35], v[112:115], v[80:95]
    v_exp_f32 v56, v56
    v_exp_f32 v57, v57
    v_cvt_pk_bf16_f32 v43, v54, v55
    v_exp_f32 v58, v58
    v_exp_f32 v59, v59
    v_cvt_pk_bf16_f32 v44, v56, v57
    v_mfma_f32_32x32x16_bf16 v[80:95], v[36:39], v[116:119], v[80:95]
    ds_read_b128 v[32:35], v121 offset:4096
    ds_read_b128 v[36:39], v121 offset:5120
    v_exp_f32 v60, v60
    v_exp_f32 v61, v61
    v_cvt_pk_bf16_f32 v45, v58, v59
    v_exp_f32 v62, v62
    v_exp_f32 v63, v63
    v_cvt_pk_bf16_f32 v46, v60, v61
    s_nop 0
    v_cvt_pk_bf16_f32 v47, v62, v63
    s_waitcnt lgkmcnt(2)
    v_mfma_f32_32x32x16_bf16 v[48:63], v[24:27], v[16:19], v[96:111]
    v_exp_f32 v64, v64
    v_exp_f32 v65, v65
    v_exp_f32 v66, v66
    v_exp_f32 v67, v67
    v_cvt_pk_bf16_f32 v112, v64, v65
    v_mfma_f32_32x32x16_bf16 v[48:63], v[28:31], v[20:23], v[48:63]
    ds_read_b128 v[24:27], v120 offset:18432
    ds_read_b128 v[28:31], v120 offset:19456
    v_exp_f32 v68, v68
    v_exp_f32 v69, v69
    v_cvt_pk_bf16_f32 v113, v66, v67
    v_exp_f32 v70, v70
    v_exp_f32 v71, v71
    v_cvt_pk_bf16_f32 v114, v68, v69
    s_add_u32 s43, s40, 57344
    s_add_u32 m0, s41, 57344
    s_add_u32 s44, s42, 57344
    buffer_load_dwordx4 v1, s[16:19], s43 offen lds
    s_add_u32 m0, s41, 122880
    s_nop 0
    buffer_load_dwordx4 v1, s[16:19], s44 offen lds
    s_waitcnt lgkmcnt(2)
    v_mfma_f32_32x32x16_bf16 v[80:95], v[32:35], v[40:43], v[80:95]
    v_exp_f32 v72, v72
    v_exp_f32 v73, v73
    v_cvt_pk_bf16_f32 v115, v70, v71
    v_exp_f32 v74, v74
    v_exp_f32 v75, v75
    v_cvt_pk_bf16_f32 v116, v72, v73
    v_mfma_f32_32x32x16_bf16 v[80:95], v[36:39], v[44:47], v[80:95]
    ds_read_b128 v[32:35], v121 offset:6144
    ds_read_b128 v[36:39], v121 offset:7168
    v_exp_f32 v76, v76
    v_exp_f32 v77, v77
    v_cvt_pk_bf16_f32 v117, v74, v75
    v_exp_f32 v78, v78
    v_exp_f32 v79, v79
    v_cvt_pk_bf16_f32 v118, v76, v77
    s_nop 0
    v_cvt_pk_bf16_f32 v119, v78, v79
    s_waitcnt lgkmcnt(2)
    v_mfma_f32_32x32x16_bf16 v[64:79], v[24:27], v[16:19], v[96:111]
    v_exp_f32 v48, v48
    v_exp_f32 v49, v49
    v_exp_f32 v50, v50
    v_exp_f32 v51, v51
    v_cvt_pk_bf16_f32 v40, v48, v49
    v_mfma_f32_32x32x16_bf16 v[64:79], v[28:31], v[20:23], v[64:79]
    ds_read_b128 v[24:27], v120 offset:20480
    ds_read_b128 v[28:31], v120 offset:21504
    v_exp_f32 v52, v52
    v_exp_f32 v53, v53
    v_cvt_pk_bf16_f32 v41, v50, v51
    v_exp_f32 v54, v54
    v_exp_f32 v55, v55
    v_cvt_pk_bf16_f32 v42, v52, v53
    s_waitcnt lgkmcnt(2)
    v_mfma_f32_32x32x16_bf16 v[80:95], v[32:35], v[112:115], v[80:95]
    v_exp_f32 v56, v56
    v_exp_f32 v57, v57
    v_cvt_pk_bf16_f32 v43, v54, v55
    v_exp_f32 v58, v58
    v_exp_f32 v59, v59
    v_cvt_pk_bf16_f32 v44, v56, v57
    v_mfma_f32_32x32x16_bf16 v[80:95], v[36:39], v[116:119], v[80:95]
    ds_read_b128 v[32:35], v121 offset:16384
    ds_read_b128 v[36:39], v121 offset:17408
    v_exp_f32 v60, v60
    v_exp_f32 v61, v61
    v_cvt_pk_bf16_f32 v45, v58, v59
    v_exp_f32 v62, v62
    v_exp_f32 v63, v63
    v_cvt_pk_bf16_f32 v46, v60, v61
    s_nop 0
    v_cvt_pk_bf16_f32 v47, v62, v63
    s_waitcnt lgkmcnt(2)
    v_mfma_f32_32x32x16_bf16 v[48:63], v[24:27], v[16:19], v[96:111]
    v_exp_f32 v64, v64
    v_exp_f32 v65, v65
    v_exp_f32 v66, v66
    v_exp_f32 v67, v67
    v_cvt_pk_bf16_f32 v112, v64, v65
    v_mfma_f32_32x32x16_bf16 v[48:63], v[28:31], v[20:23], v[48:63]
    ds_read_b128 v[24:27], v120 offset:22528
    ds_read_b128 v[28:31], v120 offset:23552
    v_exp_f32 v68, v68
    v_exp_f32 v69, v69
    v_cvt_pk_bf16_f32 v113, v66, v67
    v_exp_f32 v70, v70
    v_exp_f32 v71, v71
    v_cvt_pk_bf16_f32 v114, v68, v69
    s_waitcnt lgkmcnt(2)
    v_mfma_f32_32x32x16_bf16 v[80:95], v[32:35], v[40:43], v[80:95]
    v_exp_f32 v72, v72
    v_exp_f32 v73, v73
    v_cvt_pk_bf16_f32 v115, v70, v71
    v_exp_f32 v74, v74
    v_exp_f32 v75, v75
    v_cvt_pk_bf16_f32 v116, v72, v73
    v_mfma_f32_32x32x16_bf16 v[80:95], v[36:39], v[44:47], v[80:95]
    ds_read_b128 v[32:35], v121 offset:18432
    ds_read_b128 v[36:39], v121 offset:19456
    v_exp_f32 v76, v76
    v_exp_f32 v77, v77
    v_cvt_pk_bf16_f32 v117, v74, v75
    v_exp_f32 v78, v78
    v_exp_f32 v79, v79
    v_cvt_pk_bf16_f32 v118, v76, v77
    s_nop 0
    v_cvt_pk_bf16_f32 v119, v78, v79
    s_waitcnt vmcnt(4)
    s_barrier
    s_waitcnt lgkmcnt(2)
    v_mfma_f32_32x32x16_bf16 v[64:79], v[24:27], v[16:19], v[96:111]
    v_exp_f32 v48, v48
    v_exp_f32 v49, v49
    v_exp_f32 v50, v50
    v_exp_f32 v51, v51
    v_cvt_pk_bf16_f32 v40, v48, v49
    v_mfma_f32_32x32x16_bf16 v[64:79], v[28:31], v[20:23], v[64:79]
    ds_read_b128 v[24:27], v120 offset:32768
    ds_read_b128 v[28:31], v120 offset:33792
    v_exp_f32 v52, v52
    v_exp_f32 v53, v53
    v_cvt_pk_bf16_f32 v41, v50, v51
    v_exp_f32 v54, v54
    v_exp_f32 v55, v55
    v_cvt_pk_bf16_f32 v42, v52, v53
    s_add_u32 s43, s40, 65536
    s_add_u32 m0, s41, 0
    s_add_u32 s44, s42, 65536
    buffer_load_dwordx4 v1, s[16:19], s43 offen lds
    s_add_u32 m0, s41, 65536
    s_nop 0
    buffer_load_dwordx4 v1, s[16:19], s44 offen lds
    s_waitcnt lgkmcnt(2)
    v_mfma_f32_32x32x16_bf16 v[80:95], v[32:35], v[112:115], v[80:95]
    v_exp_f32 v56, v56
    v_exp_f32 v57, v57
    v_cvt_pk_bf16_f32 v43, v54, v55
    v_exp_f32 v58, v58
    v_exp_f32 v59, v59
    v_cvt_pk_bf16_f32 v44, v56, v57
    v_mfma_f32_32x32x16_bf16 v[80:95], v[36:39], v[116:119], v[80:95]
    ds_read_b128 v[32:35], v121 offset:20480
    ds_read_b128 v[36:39], v121 offset:21504
    v_exp_f32 v60, v60
    v_exp_f32 v61, v61
    v_cvt_pk_bf16_f32 v45, v58, v59
    v_exp_f32 v62, v62
    v_exp_f32 v63, v63
    v_cvt_pk_bf16_f32 v46, v60, v61
    s_nop 0
    v_cvt_pk_bf16_f32 v47, v62, v63
    s_waitcnt lgkmcnt(2)
    v_mfma_f32_32x32x16_bf16 v[48:63], v[24:27], v[16:19], v[96:111]
    v_exp_f32 v64, v64
    v_exp_f32 v65, v65
    v_exp_f32 v66, v66
    v_exp_f32 v67, v67
    v_cvt_pk_bf16_f32 v112, v64, v65
    v_mfma_f32_32x32x16_bf16 v[48:63], v[28:31], v[20:23], v[48:63]
    ds_read_b128 v[24:27], v120 offset:34816
    ds_read_b128 v[28:31], v120 offset:35840
    v_exp_f32 v68, v68
    v_exp_f32 v69, v69
    v_cvt_pk_bf16_f32 v113, v66, v67
    v_exp_f32 v70, v70
    v_exp_f32 v71, v71
    v_cvt_pk_bf16_f32 v114, v68, v69
    s_add_u32 s43, s40, 73728
    s_add_u32 m0, s41, 8192
    s_add_u32 s44, s42, 73728
    buffer_load_dwordx4 v1, s[16:19], s43 offen lds
    s_add_u32 m0, s41, 73728
    s_nop 0
    buffer_load_dwordx4 v1, s[16:19], s44 offen lds
    s_waitcnt lgkmcnt(2)
    v_mfma_f32_32x32x16_bf16 v[80:95], v[32:35], v[40:43], v[80:95]
    v_exp_f32 v72, v72
    v_exp_f32 v73, v73
    v_cvt_pk_bf16_f32 v115, v70, v71
    v_exp_f32 v74, v74
    v_exp_f32 v75, v75
    v_cvt_pk_bf16_f32 v116, v72, v73
    v_mfma_f32_32x32x16_bf16 v[80:95], v[36:39], v[44:47], v[80:95]
    ds_read_b128 v[32:35], v121 offset:22528
    ds_read_b128 v[36:39], v121 offset:23552
    v_exp_f32 v76, v76
    v_exp_f32 v77, v77
    v_cvt_pk_bf16_f32 v117, v74, v75
    v_exp_f32 v78, v78
    v_exp_f32 v79, v79
    v_cvt_pk_bf16_f32 v118, v76, v77
    s_nop 0
    v_cvt_pk_bf16_f32 v119, v78, v79
    s_waitcnt lgkmcnt(2)
    v_mfma_f32_32x32x16_bf16 v[64:79], v[24:27], v[16:19], v[96:111]
    v_exp_f32 v48, v48
    v_exp_f32 v49, v49
    v_exp_f32 v50, v50
    v_exp_f32 v51, v51
    v_cvt_pk_bf16_f32 v40, v48, v49
    v_mfma_f32_32x32x16_bf16 v[64:79], v[28:31], v[20:23], v[64:79]
    ds_read_b128 v[24:27], v120 offset:36864
    ds_read_b128 v[28:31], v120 offset:37888
    v_exp_f32 v52, v52
    v_exp_f32 v53, v53
    v_cvt_pk_bf16_f32 v41, v50, v51
    v_exp_f32 v54, v54
    v_exp_f32 v55, v55
    v_cvt_pk_bf16_f32 v42, v52, v53
    s_waitcnt lgkmcnt(2)
    v_mfma_f32_32x32x16_bf16 v[80:95], v[32:35], v[112:115], v[80:95]
    v_exp_f32 v56, v56
    v_exp_f32 v57, v57
    v_cvt_pk_bf16_f32 v43, v54, v55
    v_exp_f32 v58, v58
    v_exp_f32 v59, v59
    v_cvt_pk_bf16_f32 v44, v56, v57
    v_mfma_f32_32x32x16_bf16 v[80:95], v[36:39], v[116:119], v[80:95]
    ds_read_b128 v[32:35], v121 offset:32768
    ds_read_b128 v[36:39], v121 offset:33792
    v_exp_f32 v60, v60
    v_exp_f32 v61, v61
    v_cvt_pk_bf16_f32 v45, v58, v59
    v_exp_f32 v62, v62
    v_exp_f32 v63, v63
    v_cvt_pk_bf16_f32 v46, v60, v61
    s_nop 0
    v_cvt_pk_bf16_f32 v47, v62, v63
    s_waitcnt lgkmcnt(2)
    v_mfma_f32_32x32x16_bf16 v[48:63], v[24:27], v[16:19], v[96:111]
    v_exp_f32 v64, v64
    v_exp_f32 v65, v65
    v_exp_f32 v66, v66
    v_exp_f32 v67, v67
    v_cvt_pk_bf16_f32 v112, v64, v65
    v_mfma_f32_32x32x16_bf16 v[48:63], v[28:31], v[20:23], v[48:63]
    ds_read_b128 v[24:27], v120 offset:38912
    ds_read_b128 v[28:31], v120 offset:39936
    v_exp_f32 v68, v68
    v_exp_f32 v69, v69
    v_cvt_pk_bf16_f32 v113, v66, v67
    v_exp_f32 v70, v70
    v_exp_f32 v71, v71
    v_cvt_pk_bf16_f32 v114, v68, v69
    s_waitcnt lgkmcnt(2)
    v_mfma_f32_32x32x16_bf16 v[80:95], v[32:35], v[40:43], v[80:95]
    v_exp_f32 v72, v72
    v_exp_f32 v73, v73
    v_cvt_pk_bf16_f32 v115, v70, v71
    v_exp_f32 v74, v74
    v_exp_f32 v75, v75
    v_cvt_pk_bf16_f32 v116, v72, v73
    v_mfma_f32_32x32x16_bf16 v[80:95], v[36:39], v[44:47], v[80:95]
    ds_read_b128 v[32:35], v121 offset:34816
    ds_read_b128 v[36:39], v121 offset:35840
    v_exp_f32 v76, v76
    v_exp_f32 v77, v77
    v_cvt_pk_bf16_f32 v117, v74, v75
    v_exp_f32 v78, v78
    v_exp_f32 v79, v79
    v_cvt_pk_bf16_f32 v118, v76, v77
    s_nop 0
    v_cvt_pk_bf16_f32 v119, v78, v79
    s_waitcnt vmcnt(4)
    s_barrier
    s_waitcnt lgkmcnt(2)
    v_mfma_f32_32x32x16_bf16 v[64:79], v[24:27], v[16:19], v[96:111]
    v_exp_f32 v48, v48
    v_exp_f32 v49, v49
    v_exp_f32 v50, v50
    v_exp_f32 v51, v51
    v_cvt_pk_bf16_f32 v40, v48, v49
    v_mfma_f32_32x32x16_bf16 v[64:79], v[28:31], v[20:23], v[64:79]
    ds_read_b128 v[24:27], v120 offset:49152
    ds_read_b128 v[28:31], v120 offset:50176
    v_exp_f32 v52, v52
    v_exp_f32 v53, v53
    v_cvt_pk_bf16_f32 v41, v50, v51
    v_exp_f32 v54, v54
    v_exp_f32 v55, v55
    v_cvt_pk_bf16_f32 v42, v52, v53
    s_add_u32 s43, s40, 81920
    s_add_u32 m0, s41, 16384
    s_add_u32 s44, s42, 81920
    buffer_load_dwordx4 v1, s[16:19], s43 offen lds
    s_add_u32 m0, s41, 81920
    s_nop 0
    buffer_load_dwordx4 v1, s[16:19], s44 offen lds
    s_waitcnt lgkmcnt(2)
    v_mfma_f32_32x32x16_bf16 v[80:95], v[32:35], v[112:115], v[80:95]
    v_exp_f32 v56, v56
    v_exp_f32 v57, v57
    v_cvt_pk_bf16_f32 v43, v54, v55
    v_exp_f32 v58, v58
    v_exp_f32 v59, v59
    v_cvt_pk_bf16_f32 v44, v56, v57
    v_mfma_f32_32x32x16_bf16 v[80:95], v[36:39], v[116:119], v[80:95]
    ds_read_b128 v[32:35], v121 offset:36864
    ds_read_b128 v[36:39], v121 offset:37888
    v_exp_f32 v60, v60
    v_exp_f32 v61, v61
    v_cvt_pk_bf16_f32 v45, v58, v59
    v_exp_f32 v62, v62
    v_exp_f32 v63, v63
    v_cvt_pk_bf16_f32 v46, v60, v61
    s_nop 0
    v_cvt_pk_bf16_f32 v47, v62, v63
    s_waitcnt lgkmcnt(2)
    v_mfma_f32_32x32x16_bf16 v[48:63], v[24:27], v[16:19], v[96:111]
    v_exp_f32 v64, v64
    v_exp_f32 v65, v65
    v_exp_f32 v66, v66
    v_exp_f32 v67, v67
    v_cvt_pk_bf16_f32 v112, v64, v65
    v_mfma_f32_32x32x16_bf16 v[48:63], v[28:31], v[20:23], v[48:63]
    ds_read_b128 v[24:27], v120 offset:51200
    ds_read_b128 v[28:31], v120 offset:52224
    v_exp_f32 v68, v68
    v_exp_f32 v69, v69
    v_cvt_pk_bf16_f32 v113, v66, v67
    v_exp_f32 v70, v70
    v_exp_f32 v71, v71
    v_cvt_pk_bf16_f32 v114, v68, v69
    s_add_u32 s43, s40, 90112
    s_add_u32 m0, s41, 24576
    s_add_u32 s44, s42, 90112
    buffer_load_dwordx4 v1, s[16:19], s43 offen lds
    s_add_u32 m0, s41, 90112
    s_nop 0
    buffer_load_dwordx4 v1, s[16:19], s44 offen lds
    s_waitcnt lgkmcnt(2)
    v_mfma_f32_32x32x16_bf16 v[80:95], v[32:35], v[40:43], v[80:95]
    v_exp_f32 v72, v72
    v_exp_f32 v73, v73
    v_cvt_pk_bf16_f32 v115, v70, v71
    v_exp_f32 v74, v74
    v_exp_f32 v75, v75
    v_cvt_pk_bf16_f32 v116, v72, v73
    v_mfma_f32_32x32x16_bf16 v[80:95], v[36:39], v[44:47], v[80:95]
    ds_read_b128 v[32:35], v121 offset:38912
    ds_read_b128 v[36:39], v121 offset:39936
    v_exp_f32 v76, v76
    v_exp_f32 v77, v77
    v_cvt_pk_bf16_f32 v117, v74, v75
    v_exp_f32 v78, v78
    v_exp_f32 v79, v79
    v_cvt_pk_bf16_f32 v118, v76, v77
    s_nop 0
    v_cvt_pk_bf16_f32 v119, v78, v79
    s_waitcnt lgkmcnt(2)
    v_mfma_f32_32x32x16_bf16 v[64:79], v[24:27], v[16:19], v[96:111]
    v_exp_f32 v48, v48
    v_exp_f32 v49, v49
    v_exp_f32 v50, v50
    v_exp_f32 v51, v51
    v_cvt_pk_bf16_f32 v40, v48, v49
    v_mfma_f32_32x32x16_bf16 v[64:79], v[28:31], v[20:23], v[64:79]
    ds_read_b128 v[24:27], v120 offset:53248
    ds_read_b128 v[28:31], v120 offset:54272
    v_exp_f32 v52, v52
    v_exp_f32 v53, v53
    v_cvt_pk_bf16_f32 v41, v50, v51
    v_exp_f32 v54, v54
    v_exp_f32 v55, v55
    v_cvt_pk_bf16_f32 v42, v52, v53
    s_waitcnt lgkmcnt(2)
    v_mfma_f32_32x32x16_bf16 v[80:95], v[32:35], v[112:115], v[80:95]
    v_exp_f32 v56, v56
    v_exp_f32 v57, v57
    v_cvt_pk_bf16_f32 v43, v54, v55
    v_exp_f32 v58, v58
    v_exp_f32 v59, v59
    v_cvt_pk_bf16_f32 v44, v56, v57
    v_mfma_f32_32x32x16_bf16 v[80:95], v[36:39], v[116:119], v[80:95]
    ds_read_b128 v[32:35], v121 offset:49152
    ds_read_b128 v[36:39], v121 offset:50176
    v_exp_f32 v60, v60
    v_exp_f32 v61, v61
    v_cvt_pk_bf16_f32 v45, v58, v59
    v_exp_f32 v62, v62
    v_exp_f32 v63, v63
    v_cvt_pk_bf16_f32 v46, v60, v61
    s_nop 0
    v_cvt_pk_bf16_f32 v47, v62, v63
    s_waitcnt lgkmcnt(2)
    v_mfma_f32_32x32x16_bf16 v[48:63], v[24:27], v[16:19], v[96:111]
    v_exp_f32 v64, v64
    v_exp_f32 v65, v65
    v_exp_f32 v66, v66
    v_exp_f32 v67, v67
    v_cvt_pk_bf16_f32 v112, v64, v65
    v_mfma_f32_32x32x16_bf16 v[48:63], v[28:31], v[20:23], v[48:63]
    ds_read_b128 v[24:27], v120 offset:55296
    ds_read_b128 v[28:31], v120 offset:56320
    v_exp_f32 v68, v68
    v_exp_f32 v69, v69
    v_cvt_pk_bf16_f32 v113, v66, v67
    v_exp_f32 v70, v70
    v_exp_f32 v71, v71
    v_cvt_pk_bf16_f32 v114, v68, v69
    s_waitcnt lgkmcnt(2)
    v_mfma_f32_32x32x16_bf16 v[80:95], v[32:35], v[40:43], v[80:95]
    v_exp_f32 v72, v72
    v_exp_f32 v73, v73
    v_cvt_pk_bf16_f32 v115, v70, v71
    v_exp_f32 v74, v74
    v_exp_f32 v75, v75
    v_cvt_pk_bf16_f32 v116, v72, v73
    v_mfma_f32_32x32x16_bf16 v[80:95], v[36:39], v[44:47], v[80:95]
    ds_read_b128 v[32:35], v121 offset:51200
    ds_read_b128 v[36:39], v121 offset:52224
    v_exp_f32 v76, v76
    v_exp_f32 v77, v77
    v_cvt_pk_bf16_f32 v117, v74, v75
    v_exp_f32 v78, v78
    v_exp_f32 v79, v79
    v_cvt_pk_bf16_f32 v118, v76, v77
    s_nop 0
    v_cvt_pk_bf16_f32 v119, v78, v79
    s_waitcnt vmcnt(4)
    s_barrier
    s_waitcnt lgkmcnt(2)
    v_mfma_f32_32x32x16_bf16 v[64:79], v[24:27], v[16:19], v[96:111]
    v_exp_f32 v48, v48
    v_exp_f32 v49, v49
    v_exp_f32 v50, v50
    v_exp_f32 v51, v51
    v_cvt_pk_bf16_f32 v40, v48, v49
    v_mfma_f32_32x32x16_bf16 v[64:79], v[28:31], v[20:23], v[64:79]
    ds_read_b128 v[24:27], v120 offset:0
    ds_read_b128 v[28:31], v120 offset:1024
    v_exp_f32 v52, v52
    v_exp_f32 v53, v53
    v_cvt_pk_bf16_f32 v41, v50, v51
    v_exp_f32 v54, v54
    v_exp_f32 v55, v55
    v_cvt_pk_bf16_f32 v42, v52, v53
    s_add_u32 s43, s40, 98304
    s_add_u32 m0, s41, 32768
    s_add_u32 s44, s42, 98304
    buffer_load_dwordx4 v1, s[16:19], s43 offen lds
    s_add_u32 m0, s41, 98304
    s_nop 0
    buffer_load_dwordx4 v1, s[16:19], s44 offen lds
    s_waitcnt lgkmcnt(2)
    v_mfma_f32_32x32x16_bf16 v[80:95], v[32:35], v[112:115], v[80:95]
    v_exp_f32 v56, v56
    v_exp_f32 v57, v57
    v_cvt_pk_bf16_f32 v43, v54, v55
    v_exp_f32 v58, v58
    v_exp_f32 v59, v59
    v_cvt_pk_bf16_f32 v44, v56, v57
    v_mfma_f32_32x32x16_bf16 v[80:95], v[36:39], v[116:119], v[80:95]
    ds_read_b128 v[32:35], v121 offset:53248
    ds_read_b128 v[36:39], v121 offset:54272
    v_exp_f32 v60, v60
    v_exp_f32 v61, v61
    v_cvt_pk_bf16_f32 v45, v58, v59
    v_exp_f32 v62, v62
    v_exp_f32 v63, v63
    v_cvt_pk_bf16_f32 v46, v60, v61
    s_nop 0
    v_cvt_pk_bf16_f32 v47, v62, v63
    s_waitcnt lgkmcnt(2)
    v_mfma_f32_32x32x16_bf16 v[48:63], v[24:27], v[16:19], v[96:111]
    v_exp_f32 v64, v64
    v_exp_f32 v65, v65
    v_exp_f32 v66, v66
    v_exp_f32 v67, v67
    v_cvt_pk_bf16_f32 v112, v64, v65
    v_mfma_f32_32x32x16_bf16 v[48:63], v[28:31], v[20:23], v[48:63]
    ds_read_b128 v[24:27], v120 offset:2048
    ds_read_b128 v[28:31], v120 offset:3072
    v_exp_f32 v68, v68
    v_exp_f32 v69, v69
    v_cvt_pk_bf16_f32 v113, v66, v67
    v_exp_f32 v70, v70
    v_exp_f32 v71, v71
    v_cvt_pk_bf16_f32 v114, v68, v69
    s_add_u32 s43, s40, 106496
    s_add_u32 m0, s41, 40960
    s_add_u32 s44, s42, 106496
    buffer_load_dwordx4 v1, s[16:19], s43 offen lds
    s_add_u32 m0, s41, 106496
    s_nop 0
    buffer_load_dwordx4 v1, s[16:19], s44 offen lds
    s_waitcnt lgkmcnt(2)
    v_mfma_f32_32x32x16_bf16 v[80:95], v[32:35], v[40:43], v[80:95]
    v_exp_f32 v72, v72
    v_exp_f32 v73, v73
    v_cvt_pk_bf16_f32 v115, v70, v71
    v_exp_f32 v74, v74
    v_exp_f32 v75, v75
    v_cvt_pk_bf16_f32 v116, v72, v73
    v_mfma_f32_32x32x16_bf16 v[80:95], v[36:39], v[44:47], v[80:95]
    ds_read_b128 v[32:35], v121 offset:55296
    ds_read_b128 v[36:39], v121 offset:56320
    v_exp_f32 v76, v76
    v_exp_f32 v77, v77
    v_cvt_pk_bf16_f32 v117, v74, v75
    v_exp_f32 v78, v78
    v_exp_f32 v79, v79
    v_cvt_pk_bf16_f32 v118, v76, v77
    s_nop 0
    v_cvt_pk_bf16_f32 v119, v78, v79
    s_waitcnt lgkmcnt(2)
    v_mfma_f32_32x32x16_bf16 v[64:79], v[24:27], v[16:19], v[96:111]
    v_exp_f32 v48, v48
    v_exp_f32 v49, v49
    v_exp_f32 v50, v50
    v_exp_f32 v51, v51
    v_cvt_pk_bf16_f32 v40, v48, v49
    v_mfma_f32_32x32x16_bf16 v[64:79], v[28:31], v[20:23], v[64:79]
    ds_read_b128 v[24:27], v120 offset:4096
    ds_read_b128 v[28:31], v120 offset:5120
    v_exp_f32 v52, v52
    v_exp_f32 v53, v53
    v_cvt_pk_bf16_f32 v41, v50, v51
    v_exp_f32 v54, v54
    v_exp_f32 v55, v55
    v_cvt_pk_bf16_f32 v42, v52, v53
    s_waitcnt lgkmcnt(2)
    v_mfma_f32_32x32x16_bf16 v[80:95], v[32:35], v[112:115], v[80:95]
    v_exp_f32 v56, v56
    v_exp_f32 v57, v57
    v_cvt_pk_bf16_f32 v43, v54, v55
    v_exp_f32 v58, v58
    v_exp_f32 v59, v59
    v_cvt_pk_bf16_f32 v44, v56, v57
    v_mfma_f32_32x32x16_bf16 v[80:95], v[36:39], v[116:119], v[80:95]
    ds_read_b128 v[32:35], v121 offset:0
    ds_read_b128 v[36:39], v121 offset:1024
    v_exp_f32 v60, v60
    v_exp_f32 v61, v61
    v_cvt_pk_bf16_f32 v45, v58, v59
    v_exp_f32 v62, v62
    v_exp_f32 v63, v63
    v_cvt_pk_bf16_f32 v46, v60, v61
    s_nop 0
    v_cvt_pk_bf16_f32 v47, v62, v63
    s_waitcnt lgkmcnt(2)
    v_mfma_f32_32x32x16_bf16 v[48:63], v[24:27], v[16:19], v[96:111]
    v_exp_f32 v64, v64
    v_exp_f32 v65, v65
    v_exp_f32 v66, v66
    v_exp_f32 v67, v67
    v_cvt_pk_bf16_f32 v112, v64, v65
    v_mfma_f32_32x32x16_bf16 v[48:63], v[28:31], v[20:23], v[48:63]
    ds_read_b128 v[24:27], v120 offset:6144
    ds_read_b128 v[28:31], v120 offset:7168
    v_exp_f32 v68, v68
    v_exp_f32 v69, v69
    v_cvt_pk_bf16_f32 v113, v66, v67
    v_exp_f32 v70, v70
    v_exp_f32 v71, v71
    v_cvt_pk_bf16_f32 v114, v68, v69
    s_waitcnt lgkmcnt(2)
    v_mfma_f32_32x32x16_bf16 v[80:95], v[32:35], v[40:43], v[80:95]
    v_exp_f32 v72, v72
    v_exp_f32 v73, v73
    v_cvt_pk_bf16_f32 v115, v70, v71
    v_exp_f32 v74, v74
    v_exp_f32 v75, v75
    v_cvt_pk_bf16_f32 v116, v72, v73
    v_mfma_f32_32x32x16_bf16 v[80:95], v[36:39], v[44:47], v[80:95]
    ds_read_b128 v[32:35], v121 offset:2048
    ds_read_b128 v[36:39], v121 offset:3072
    v_exp_f32 v76, v76
    v_exp_f32 v77, v77
    v_cvt_pk_bf16_f32 v117, v74, v75
    v_exp_f32 v78, v78
    v_exp_f32 v79, v79
    v_cvt_pk_bf16_f32 v118, v76, v77
    s_nop 0
    v_cvt_pk_bf16_f32 v119, v78, v79
    s_waitcnt vmcnt(4)
    s_barrier
    s_waitcnt lgkmcnt(2)
    v_mfma_f32_32x32x16_bf16 v[64:79], v[24:27], v[16:19], v[96:111]
    v_exp_f32 v48, v48
    v_exp_f32 v49, v49
    v_exp_f32 v50, v50
    v_exp_f32 v51, v51
    v_cvt_pk_bf16_f32 v40, v48, v49
    v_mfma_f32_32x32x16_bf16 v[64:79], v[28:31], v[20:23], v[64:79]
    ds_read_b128 v[24:27], v120 offset:16384
    ds_read_b128 v[28:31], v120 offset:17408
    v_exp_f32 v52, v52
    v_exp_f32 v53, v53
    v_cvt_pk_bf16_f32 v41, v50, v51
    v_exp_f32 v54, v54
    v_exp_f32 v55, v55
    v_cvt_pk_bf16_f32 v42, v52, v53
    s_add_u32 s43, s40, 114688
    s_add_u32 m0, s41, 49152
    s_add_u32 s44, s42, 114688
    buffer_load_dwordx4 v1, s[16:19], s43 offen lds
    s_add_u32 m0, s41, 114688
    s_nop 0
    buffer_load_dwordx4 v1, s[16:19], s44 offen lds
    s_waitcnt lgkmcnt(2)
    v_mfma_f32_32x32x16_bf16 v[80:95], v[32:35], v[112:115], v[80:95]
    v_exp_f32 v56, v56
    v_exp_f32 v57, v57
    v_cvt_pk_bf16_f32 v43, v54, v55
    v_exp_f32 v58, v58
    v_exp_f32 v59, v59
    v_cvt_pk_bf16_f32 v44, v56, v57
    v_mfma_f32_32x32x16_bf16 v[80:95], v[36:39], v[116:119], v[80:95]
    ds_read_b128 v[32:35], v121 offset:4096
    ds_read_b128 v[36:39], v121 offset:5120
    v_exp_f32 v60, v60
    v_exp_f32 v61, v61
    v_cvt_pk_bf16_f32 v45, v58, v59
    v_exp_f32 v62, v62
    v_exp_f32 v63, v63
    v_cvt_pk_bf16_f32 v46, v60, v61
    s_nop 0
    v_cvt_pk_bf16_f32 v47, v62, v63
    s_waitcnt lgkmcnt(2)
    v_mfma_f32_32x32x16_bf16 v[48:63], v[24:27], v[16:19], v[96:111]
    v_exp_f32 v64, v64
    v_exp_f32 v65, v65
    v_exp_f32 v66, v66
    v_exp_f32 v67, v67
    v_cvt_pk_bf16_f32 v112, v64, v65
    v_mfma_f32_32x32x16_bf16 v[48:63], v[28:31], v[20:23], v[48:63]
    ds_read_b128 v[24:27], v120 offset:18432
    ds_read_b128 v[28:31], v120 offset:19456
    v_exp_f32 v68, v68
    v_exp_f32 v69, v69
    v_cvt_pk_bf16_f32 v113, v66, v67
    v_exp_f32 v70, v70
    v_exp_f32 v71, v71
    v_cvt_pk_bf16_f32 v114, v68, v69
    s_add_u32 s43, s40, 122880
    s_add_u32 m0, s41, 57344
    s_add_u32 s44, s42, 122880
    buffer_load_dwordx4 v1, s[16:19], s43 offen lds
    s_add_u32 m0, s41, 122880
    s_nop 0
    buffer_load_dwordx4 v1, s[16:19], s44 offen lds
    s_waitcnt lgkmcnt(2)
    v_mfma_f32_32x32x16_bf16 v[80:95], v[32:35], v[40:43], v[80:95]
    v_exp_f32 v72, v72
    v_exp_f32 v73, v73
    v_cvt_pk_bf16_f32 v115, v70, v71
    v_exp_f32 v74, v74
    v_exp_f32 v75, v75
    v_cvt_pk_bf16_f32 v116, v72, v73
    v_mfma_f32_32x32x16_bf16 v[80:95], v[36:39], v[44:47], v[80:95]
    ds_read_b128 v[32:35], v121 offset:6144
    ds_read_b128 v[36:39], v121 offset:7168
    v_exp_f32 v76, v76
    v_exp_f32 v77, v77
    v_cvt_pk_bf16_f32 v117, v74, v75
    v_exp_f32 v78, v78
    v_exp_f32 v79, v79
    v_cvt_pk_bf16_f32 v118, v76, v77
    s_nop 0
    v_cvt_pk_bf16_f32 v119, v78, v79
    s_waitcnt lgkmcnt(2)
    v_mfma_f32_32x32x16_bf16 v[64:79], v[24:27], v[16:19], v[96:111]
    v_exp_f32 v48, v48
    v_exp_f32 v49, v49
    v_exp_f32 v50, v50
    v_exp_f32 v51, v51
    v_cvt_pk_bf16_f32 v40, v48, v49
    v_mfma_f32_32x32x16_bf16 v[64:79], v[28:31], v[20:23], v[64:79]
    ds_read_b128 v[24:27], v120 offset:20480
    ds_read_b128 v[28:31], v120 offset:21504
    v_exp_f32 v52, v52
    v_exp_f32 v53, v53
    v_cvt_pk_bf16_f32 v41, v50, v51
    v_exp_f32 v54, v54
    v_exp_f32 v55, v55
    v_cvt_pk_bf16_f32 v42, v52, v53
    s_waitcnt lgkmcnt(2)
    v_mfma_f32_32x32x16_bf16 v[80:95], v[32:35], v[112:115], v[80:95]
    v_exp_f32 v56, v56
    v_exp_f32 v57, v57
    v_cvt_pk_bf16_f32 v43, v54, v55
    v_exp_f32 v58, v58
    v_exp_f32 v59, v59
    v_cvt_pk_bf16_f32 v44, v56, v57
    v_mfma_f32_32x32x16_bf16 v[80:95], v[36:39], v[116:119], v[80:95]
    ds_read_b128 v[32:35], v121 offset:16384
    ds_read_b128 v[36:39], v121 offset:17408
    v_exp_f32 v60, v60
    v_exp_f32 v61, v61
    v_cvt_pk_bf16_f32 v45, v58, v59
    v_exp_f32 v62, v62
    v_exp_f32 v63, v63
    v_cvt_pk_bf16_f32 v46, v60, v61
    s_nop 0
    v_cvt_pk_bf16_f32 v47, v62, v63
    s_waitcnt lgkmcnt(2)
    v_mfma_f32_32x32x16_bf16 v[48:63], v[24:27], v[16:19], v[96:111]
    v_exp_f32 v64, v64
    v_exp_f32 v65, v65
    v_exp_f32 v66, v66
    v_exp_f32 v67, v67
    v_cvt_pk_bf16_f32 v112, v64, v65
    v_mfma_f32_32x32x16_bf16 v[48:63], v[28:31], v[20:23], v[48:63]
    ds_read_b128 v[24:27], v120 offset:22528
    ds_read_b128 v[28:31], v120 offset:23552
    v_exp_f32 v68, v68
    v_exp_f32 v69, v69
    v_cvt_pk_bf16_f32 v113, v66, v67
    v_exp_f32 v70, v70
    v_exp_f32 v71, v71
    v_cvt_pk_bf16_f32 v114, v68, v69
    s_waitcnt lgkmcnt(2)
    v_mfma_f32_32x32x16_bf16 v[80:95], v[32:35], v[40:43], v[80:95]
    v_exp_f32 v72, v72
    v_exp_f32 v73, v73
    v_cvt_pk_bf16_f32 v115, v70, v71
    v_exp_f32 v74, v74
    v_exp_f32 v75, v75
    v_cvt_pk_bf16_f32 v116, v72, v73
    v_mfma_f32_32x32x16_bf16 v[80:95], v[36:39], v[44:47], v[80:95]
    ds_read_b128 v[32:35], v121 offset:18432
    ds_read_b128 v[36:39], v121 offset:19456
    v_exp_f32 v76, v76
    v_exp_f32 v77, v77
    v_cvt_pk_bf16_f32 v117, v74, v75
    v_exp_f32 v78, v78
    v_exp_f32 v79, v79
    v_cvt_pk_bf16_f32 v118, v76, v77
    s_nop 0
    v_cvt_pk_bf16_f32 v119, v78, v79
    s_waitcnt vmcnt(4)
    s_barrier
    s_waitcnt lgkmcnt(2)
    v_mfma_f32_32x32x16_bf16 v[64:79], v[24:27], v[16:19], v[96:111]
    v_exp_f32 v48, v48
    v_exp_f32 v49, v49
    v_exp_f32 v50, v50
    v_exp_f32 v51, v51
    v_cvt_pk_bf16_f32 v40, v48, v49
    v_mfma_f32_32x32x16_bf16 v[64:79], v[28:31], v[20:23], v[64:79]
    ds_read_b128 v[24:27], v120 offset:32768
    ds_read_b128 v[28:31], v120 offset:33792
    v_exp_f32 v52, v52
    v_exp_f32 v53, v53
    v_cvt_pk_bf16_f32 v41, v50, v51
    v_exp_f32 v54, v54
    v_exp_f32 v55, v55
    v_cvt_pk_bf16_f32 v42, v52, v53
    s_waitcnt lgkmcnt(2)
    v_mfma_f32_32x32x16_bf16 v[80:95], v[32:35], v[112:115], v[80:95]
    v_exp_f32 v56, v56
    v_exp_f32 v57, v57
    v_cvt_pk_bf16_f32 v43, v54, v55
    v_exp_f32 v58, v58
    v_exp_f32 v59, v59
    v_cvt_pk_bf16_f32 v44, v56, v57
    v_mfma_f32_32x32x16_bf16 v[80:95], v[36:39], v[116:119], v[80:95]
    ds_read_b128 v[32:35], v121 offset:20480
    ds_read_b128 v[36:39], v121 offset:21504
    v_exp_f32 v60, v60
    v_exp_f32 v61, v61
    v_cvt_pk_bf16_f32 v45, v58, v59
    v_exp_f32 v62, v62
    v_exp_f32 v63, v63
    v_cvt_pk_bf16_f32 v46, v60, v61
    s_nop 0
    v_cvt_pk_bf16_f32 v47, v62, v63
    s_waitcnt lgkmcnt(2)
    v_mfma_f32_32x32x16_bf16 v[48:63], v[24:27], v[16:19], v[96:111]
    v_exp_f32 v64, v64
    v_exp_f32 v65, v65
    v_exp_f32 v66, v66
    v_exp_f32 v67, v67
    v_cvt_pk_bf16_f32 v112, v64, v65
    v_mfma_f32_32x32x16_bf16 v[48:63], v[28:31], v[20:23], v[48:63]
    ds_read_b128 v[24:27], v120 offset:34816
    ds_read_b128 v[28:31], v120 offset:35840
    v_exp_f32 v68, v68
    v_exp_f32 v69, v69
    v_cvt_pk_bf16_f32 v113, v66, v67
    v_exp_f32 v70, v70
    v_exp_f32 v71, v71
    v_cvt_pk_bf16_f32 v114, v68, v69
    s_waitcnt lgkmcnt(2)
    v_mfma_f32_32x32x16_bf16 v[80:95], v[32:35], v[40:43], v[80:95]
    v_exp_f32 v72, v72
    v_exp_f32 v73, v73
    v_cvt_pk_bf16_f32 v115, v70, v71
    v_exp_f32 v74, v74
    v_exp_f32 v75, v75
    v_cvt_pk_bf16_f32 v116, v72, v73
    v_mfma_f32_32x32x16_bf16 v[80:95], v[36:39], v[44:47], v[80:95]
    ds_read_b128 v[32:35], v121 offset:22528
    ds_read_b128 v[36:39], v121 offset:23552
    v_exp_f32 v76, v76
    v_exp_f32 v77, v77
    v_cvt_pk_bf16_f32 v117, v74, v75
    v_exp_f32 v78, v78
    v_exp_f32 v79, v79
    v_cvt_pk_bf16_f32 v118, v76, v77
    s_nop 0
    v_cvt_pk_bf16_f32 v119, v78, v79
    s_waitcnt lgkmcnt(2)
    v_mfma_f32_32x32x16_bf16 v[64:79], v[24:27], v[16:19], v[96:111]
    v_exp_f32 v48, v48
    v_exp_f32 v49, v49
    v_exp_f32 v50, v50
    v_exp_f32 v51, v51
    v_cvt_pk_bf16_f32 v40, v48, v49
    v_mfma_f32_32x32x16_bf16 v[64:79], v[28:31], v[20:23], v[64:79]
    ds_read_b128 v[24:27], v120 offset:36864
    ds_read_b128 v[28:31], v120 offset:37888
    v_exp_f32 v52, v52
    v_exp_f32 v53, v53
    v_cvt_pk_bf16_f32 v41, v50, v51
    v_exp_f32 v54, v54
    v_exp_f32 v55, v55
    v_cvt_pk_bf16_f32 v42, v52, v53
    s_waitcnt lgkmcnt(2)
    v_mfma_f32_32x32x16_bf16 v[80:95], v[32:35], v[112:115], v[80:95]
    v_exp_f32 v56, v56
    v_exp_f32 v57, v57
    v_cvt_pk_bf16_f32 v43, v54, v55
    v_exp_f32 v58, v58
    v_exp_f32 v59, v59
    v_cvt_pk_bf16_f32 v44, v56, v57
    v_mfma_f32_32x32x16_bf16 v[80:95], v[36:39], v[116:119], v[80:95]
    ds_read_b128 v[32:35], v121 offset:32768
    ds_read_b128 v[36:39], v121 offset:33792
    v_exp_f32 v60, v60
    v_exp_f32 v61, v61
    v_cvt_pk_bf16_f32 v45, v58, v59
    v_exp_f32 v62, v62
    v_exp_f32 v63, v63
    v_cvt_pk_bf16_f32 v46, v60, v61
    s_nop 0
    v_cvt_pk_bf16_f32 v47, v62, v63
    s_waitcnt lgkmcnt(2)
    v_mfma_f32_32x32x16_bf16 v[48:63], v[24:27], v[16:19], v[96:111]
    v_exp_f32 v64, v64
    v_exp_f32 v65, v65
    v_exp_f32 v66, v66
    v_exp_f32 v67, v67
    v_cvt_pk_bf16_f32 v112, v64, v65
    v_mfma_f32_32x32x16_bf16 v[48:63], v[28:31], v[20:23], v[48:63]
    ds_read_b128 v[24:27], v120 offset:38912
    ds_read_b128 v[28:31], v120 offset:39936
    v_exp_f32 v68, v68
    v_exp_f32 v69, v69
    v_cvt_pk_bf16_f32 v113, v66, v67
    v_exp_f32 v70, v70
    v_exp_f32 v71, v71
    v_cvt_pk_bf16_f32 v114, v68, v69
    s_waitcnt lgkmcnt(2)
    v_mfma_f32_32x32x16_bf16 v[80:95], v[32:35], v[40:43], v[80:95]
    v_exp_f32 v72, v72
    v_exp_f32 v73, v73
    v_cvt_pk_bf16_f32 v115, v70, v71
    v_exp_f32 v74, v74
    v_exp_f32 v75, v75
    v_cvt_pk_bf16_f32 v116, v72, v73
    v_mfma_f32_32x32x16_bf16 v[80:95], v[36:39], v[44:47], v[80:95]
    ds_read_b128 v[32:35], v121 offset:34816
    ds_read_b128 v[36:39], v121 offset:35840
    v_exp_f32 v76, v76
    v_exp_f32 v77, v77
    v_cvt_pk_bf16_f32 v117, v74, v75
    v_exp_f32 v78, v78
    v_exp_f32 v79, v79
    v_cvt_pk_bf16_f32 v118, v76, v77
    s_nop 0
    v_cvt_pk_bf16_f32 v119, v78, v79
    s_waitcnt vmcnt(0)
    s_barrier
    buffer_load_dwordx4 v[160:163], v1, s[20:23], s64 offen
    s_cmp_lg_u32 s70, 0
    s_cbranch_scc1 Lk2_noll
    s_cmp_eq_u32 s36, 1
    s_cbranch_scc0 Lk2_noll
    s_lshl_b32 s38, s32, 6
    s_add_u32 s39, s38, s35
    s_sub_u32 s45, s35, 1
    s_max_i32 s45, s45, 0
    s_add_u32 s45, s38, s45
    s_lshl_b32 s39, s39, 11
    s_lshl_b32 s45, s45, 11
    buffer_load_dwordx4 v[124:127], v1, s[16:19], s39 offen
    buffer_load_dwordx4 v[128:131], v1, s[16:19], s39 offen offset:1024
    s_add_u32 s46, s45, 4194304
    buffer_load_dwordx4 v[132:135], v1, s[16:19], s46 offen
    buffer_load_dwordx4 v[136:139], v1, s[16:19], s46 offen offset:1024
    s_add_u32 s46, s39, 4194304
    buffer_load_dwordx4 v[140:143], v1, s[16:19], s46 offen
    buffer_load_dwordx4 v[144:147], v1, s[16:19], s46 offen offset:1024
    s_add_u32 s46, s45, 8388608
    buffer_load_dwordx4 v[148:151], v1, s[16:19], s46 offen offset:1024
    s_add_u32 s46, s39, 8388608
    buffer_load_dwordx4 v[152:155], v1, s[16:19], s46 offen
    buffer_load_dwordx4 v[156:159], v1, s[16:19], s46 offen offset:1024
Lk2_noll:
    s_waitcnt lgkmcnt(2)
    v_mfma_f32_32x32x16_bf16 v[64:79], v[24:27], v[16:19], v[96:111]
    v_exp_f32 v48, v48
    v_exp_f32 v49, v49
    v_exp_f32 v50, v50
    v_exp_f32 v51, v51
    v_cvt_pk_bf16_f32 v40, v48, v49
    v_mfma_f32_32x32x16_bf16 v[64:79], v[28:31], v[20:23], v[64:79]
    ds_read_b128 v[24:27], v120 offset:49152
    ds_read_b128 v[28:31], v120 offset:50176
    v_exp_f32 v52, v52
    v_exp_f32 v53, v53
    v_cvt_pk_bf16_f32 v41, v50, v51
    v_exp_f32 v54, v54
    v_exp_f32 v55, v55
    v_cvt_pk_bf16_f32 v42, v52, v53
    s_waitcnt lgkmcnt(2)
    v_mfma_f32_32x32x16_bf16 v[80:95], v[32:35], v[112:115], v[80:95]
    v_exp_f32 v56, v56
    v_exp_f32 v57, v57
    v_cvt_pk_bf16_f32 v43, v54, v55
    v_exp_f32 v58, v58
    v_exp_f32 v59, v59
    v_cvt_pk_bf16_f32 v44, v56, v57
    v_mfma_f32_32x32x16_bf16 v[80:95], v[36:39], v[116:119], v[80:95]
    ds_read_b128 v[32:35], v121 offset:36864
    ds_read_b128 v[36:39], v121 offset:37888
    v_exp_f32 v60, v60
    v_exp_f32 v61, v61
    v_cvt_pk_bf16_f32 v45, v58, v59
    v_exp_f32 v62, v62
    v_exp_f32 v63, v63
    v_cvt_pk_bf16_f32 v46, v60, v61
    s_nop 0
    v_cvt_pk_bf16_f32 v47, v62, v63
    s_waitcnt lgkmcnt(2)
    v_mfma_f32_32x32x16_bf16 v[48:63], v[24:27], v[16:19], v[96:111]
    v_exp_f32 v64, v64
    v_exp_f32 v65, v65
    v_exp_f32 v66, v66
    v_exp_f32 v67, v67
    v_cvt_pk_bf16_f32 v112, v64, v65
    v_mfma_f32_32x32x16_bf16 v[48:63], v[28:31], v[20:23], v[48:63]
    ds_read_b128 v[24:27], v120 offset:51200
    ds_read_b128 v[28:31], v120 offset:52224
    v_exp_f32 v68, v68
    v_exp_f32 v69, v69
    v_cvt_pk_bf16_f32 v113, v66, v67
    v_exp_f32 v70, v70
    v_exp_f32 v71, v71
    v_cvt_pk_bf16_f32 v114, v68, v69
    s_waitcnt lgkmcnt(2)
    v_mfma_f32_32x32x16_bf16 v[80:95], v[32:35], v[40:43], v[80:95]
    v_exp_f32 v72, v72
    v_exp_f32 v73, v73
    v_cvt_pk_bf16_f32 v115, v70, v71
    v_exp_f32 v74, v74
    v_exp_f32 v75, v75
    v_cvt_pk_bf16_f32 v116, v72, v73
    v_mfma_f32_32x32x16_bf16 v[80:95], v[36:39], v[44:47], v[80:95]
    ds_read_b128 v[32:35], v121 offset:38912
    ds_read_b128 v[36:39], v121 offset:39936
    v_exp_f32 v76, v76
    v_exp_f32 v77, v77
    v_cvt_pk_bf16_f32 v117, v74, v75
    v_exp_f32 v78, v78
    v_exp_f32 v79, v79
    v_cvt_pk_bf16_f32 v118, v76, v77
    s_nop 0
    v_cvt_pk_bf16_f32 v119, v78, v79
    s_waitcnt lgkmcnt(2)
    v_mfma_f32_32x32x16_bf16 v[64:79], v[24:27], v[16:19], v[96:111]
    v_exp_f32 v48, v48
    v_exp_f32 v49, v49
    v_exp_f32 v50, v50
    v_exp_f32 v51, v51
    v_cvt_pk_bf16_f32 v40, v48, v49
    v_mfma_f32_32x32x16_bf16 v[64:79], v[28:31], v[20:23], v[64:79]
    ds_read_b128 v[24:27], v120 offset:53248
    ds_read_b128 v[28:31], v120 offset:54272
    v_exp_f32 v52, v52
    v_exp_f32 v53, v53
    v_cvt_pk_bf16_f32 v41, v50, v51
    v_exp_f32 v54, v54
    v_exp_f32 v55, v55
    v_cvt_pk_bf16_f32 v42, v52, v53
    s_waitcnt lgkmcnt(2)
    v_mfma_f32_32x32x16_bf16 v[80:95], v[32:35], v[112:115], v[80:95]
    v_exp_f32 v56, v56
    v_exp_f32 v57, v57
    v_cvt_pk_bf16_f32 v43, v54, v55
    v_exp_f32 v58, v58
    v_exp_f32 v59, v59
    v_cvt_pk_bf16_f32 v44, v56, v57
    v_mfma_f32_32x32x16_bf16 v[80:95], v[36:39], v[116:119], v[80:95]
    ds_read_b128 v[32:35], v121 offset:49152
    ds_read_b128 v[36:39], v121 offset:50176
    v_exp_f32 v60, v60
    v_exp_f32 v61, v61
    v_cvt_pk_bf16_f32 v45, v58, v59
    v_exp_f32 v62, v62
    v_exp_f32 v63, v63
    v_cvt_pk_bf16_f32 v46, v60, v61
    s_nop 0
    v_cvt_pk_bf16_f32 v47, v62, v63
    s_waitcnt lgkmcnt(2)
    v_mfma_f32_32x32x16_bf16 v[48:63], v[24:27], v[16:19], v[96:111]
    v_exp_f32 v64, v64
    v_exp_f32 v65, v65
    v_exp_f32 v66, v66
    v_exp_f32 v67, v67
    v_cvt_pk_bf16_f32 v112, v64, v65
    v_mfma_f32_32x32x16_bf16 v[48:63], v[28:31], v[20:23], v[48:63]
    ds_read_b128 v[24:27], v120 offset:55296
    ds_read_b128 v[28:31], v120 offset:56320
    v_exp_f32 v68, v68
    v_exp_f32 v69, v69
    v_cvt_pk_bf16_f32 v113, v66, v67
    v_exp_f32 v70, v70
    v_exp_f32 v71, v71
    v_cvt_pk_bf16_f32 v114, v68, v69
    s_waitcnt lgkmcnt(2)
    v_mfma_f32_32x32x16_bf16 v[80:95], v[32:35], v[40:43], v[80:95]
    v_exp_f32 v72, v72
    v_exp_f32 v73, v73
    v_cvt_pk_bf16_f32 v115, v70, v71
    v_exp_f32 v74, v74
    v_exp_f32 v75, v75
    v_cvt_pk_bf16_f32 v116, v72, v73
    v_mfma_f32_32x32x16_bf16 v[80:95], v[36:39], v[44:47], v[80:95]
    ds_read_b128 v[32:35], v121 offset:51200
    ds_read_b128 v[36:39], v121 offset:52224
    v_exp_f32 v76, v76
    v_exp_f32 v77, v77
    v_cvt_pk_bf16_f32 v117, v74, v75
    v_exp_f32 v78, v78
    v_exp_f32 v79, v79
    v_cvt_pk_bf16_f32 v118, v76, v77
    s_nop 0
    v_cvt_pk_bf16_f32 v119, v78, v79
    s_waitcnt lgkmcnt(2)
    v_mfma_f32_32x32x16_bf16 v[64:79], v[24:27], v[16:19], v[96:111]
    v_exp_f32 v48, v48
    v_exp_f32 v49, v49
    v_exp_f32 v50, v50
    v_exp_f32 v51, v51
    v_cvt_pk_bf16_f32 v40, v48, v49
    v_mfma_f32_32x32x16_bf16 v[64:79], v[28:31], v[20:23], v[64:79]
    v_exp_f32 v52, v52
    v_exp_f32 v53, v53
    v_cvt_pk_bf16_f32 v41, v50, v51
    v_exp_f32 v54, v54
    v_exp_f32 v55, v55
    v_cvt_pk_bf16_f32 v42, v52, v53
    s_waitcnt lgkmcnt(0)
    v_mfma_f32_32x32x16_bf16 v[80:95], v[32:35], v[112:115], v[80:95]
    v_exp_f32 v56, v56
    v_exp_f32 v57, v57
    v_cvt_pk_bf16_f32 v43, v54, v55
    v_exp_f32 v58, v58
    v_exp_f32 v59, v59
    v_cvt_pk_bf16_f32 v44, v56, v57
    v_mfma_f32_32x32x16_bf16 v[80:95], v[36:39], v[116:119], v[80:95]
    ds_read_b128 v[32:35], v121 offset:53248
    ds_read_b128 v[36:39], v121 offset:54272
    v_exp_f32 v60, v60
    v_exp_f32 v61, v61
    v_cvt_pk_bf16_f32 v45, v58, v59
    v_exp_f32 v62, v62
    v_exp_f32 v63, v63
    v_cvt_pk_bf16_f32 v46, v60, v61
    s_nop 0
    v_cvt_pk_bf16_f32 v47, v62, v63
    v_exp_f32 v64, v64
    v_exp_f32 v65, v65
    v_exp_f32 v66, v66
    v_exp_f32 v67, v67
    v_cvt_pk_bf16_f32 v112, v64, v65
    v_exp_f32 v68, v68
    v_exp_f32 v69, v69
    v_cvt_pk_bf16_f32 v113, v66, v67
    v_exp_f32 v70, v70
    v_exp_f32 v71, v71
    v_cvt_pk_bf16_f32 v114, v68, v69
    s_waitcnt lgkmcnt(0)
    v_mfma_f32_32x32x16_bf16 v[80:95], v[32:35], v[40:43], v[80:95]
    v_exp_f32 v72, v72
    v_exp_f32 v73, v73
    v_cvt_pk_bf16_f32 v115, v70, v71
    v_exp_f32 v74, v74
    v_exp_f32 v75, v75
    v_cvt_pk_bf16_f32 v116, v72, v73
    v_mfma_f32_32x32x16_bf16 v[80:95], v[36:39], v[44:47], v[80:95]
    ds_read_b128 v[32:35], v121 offset:55296
    ds_read_b128 v[36:39], v121 offset:56320
    v_exp_f32 v76, v76
    v_exp_f32 v77, v77
    v_cvt_pk_bf16_f32 v117, v74, v75
    v_exp_f32 v78, v78
    v_exp_f32 v79, v79
    v_cvt_pk_bf16_f32 v118, v76, v77
    s_nop 0
    v_cvt_pk_bf16_f32 v119, v78, v79
    s_waitcnt lgkmcnt(0)
    s_nop 0
    v_mfma_f32_32x32x16_bf16 v[80:95], v[32:35], v[112:115], v[80:95]
    v_mfma_f32_32x32x16_bf16 v[80:95], v[36:39], v[116:119], v[80:95]
    s_and_b32 s37, s34, 3
    s_lshl_b32 s37, s37, 12
    s_add_u32 s37, s37, 131072
    v_add_u32 v6, s37, v1
    s_nop 12
    s_cmp_eq_u32 s36, 0
    s_cbranch_scc1 Lk2_e1
    ds_write_b128 v6, v[80:83] offset:0
    ds_write_b128 v6, v[84:87] offset:1024
    ds_write_b128 v6, v[88:91] offset:2048
    ds_write_b128 v6, v[92:95] offset:3072
    s_waitcnt lgkmcnt(0)
Lk2_e1:
    s_barrier
    s_cmp_eq_u32 s36, 0
    s_cbranch_scc0 Lk2_local
    s_waitcnt vmcnt(0)
    ds_read_b128 v[160:163], v6 offset:0
    ds_read_b128 v[164:167], v6 offset:1024
    ds_read_b128 v[168:171], v6 offset:2048
    ds_read_b128 v[172:175], v6 offset:3072
    s_add_u32 s46, s35, 64
    s_lshl_b32 s46, s46, 4
    s_add_u32 s46, s46, s32
    s_lshl_b32 s46, s46, 11
    s_add_u32 s46, s46, 12582912
    s_waitcnt lgkmcnt(0)
    v_add_f32 v80, v80, v160
    v_add_f32 v81, v81, v161
    v_add_f32 v82, v82, v162
    v_add_f32 v83, v83, v163
    v_add_f32 v84, v84, v164
    v_add_f32 v85, v85, v165
    v_add_f32 v86, v86, v166
    v_add_f32 v87, v87, v167
    v_add_f32 v88, v88, v168
    v_add_f32 v89, v89, v169
    v_add_f32 v90, v90, v170
    v_add_f32 v91, v91, v171
    v_add_f32 v92, v92, v172
    v_add_f32 v93, v93, v173
    v_add_f32 v94, v94, v174
    v_add_f32 v95, v95, v175
    v_mov_b32 v3, v92
    v_mov_b32 v4, v92
    s_nop 1
    v_permlane32_swap_b32 v3, v4
    v_rcp_f32 v5, v4
    v_mov_b32 v6, 0.5
    v_mov_b32 v7, 1400897536
    v_cmp_nge_f32 vcc, v4, v6
    v_cmp_nle_f32 s[60:61], v4, v7
    s_or_b64 s[60:61], s[60:61], vcc
    v_mul_f32 v80, v5, v80
    v_mul_f32 v81, v5, v81
    v_mul_f32 v82, v5, v82
    v_mul_f32 v83, v5, v83
    v_mul_f32 v84, v5, v84
    v_mul_f32 v85, v5, v85
    v_mul_f32 v86, v5, v86
    v_mul_f32 v87, v5, v87
    v_mul_f32 v88, v5, v88
    v_mul_f32 v89, v5, v89
    v_mul_f32 v90, v5, v90
    v_mul_f32 v91, v5, v91
    v_mul_f32 v92, v5, v92
    v_mul_f32 v93, v5, v93
    v_mul_f32 v94, v5, v94
    v_mul_f32 v95, v5, v95
    v_cvt_pk_bf16_f32 v40, v80, v81
    v_cvt_pk_bf16_f32 v41, v82, v83
    v_cvt_pk_bf16_f32 v42, v84, v85
    v_cvt_pk_bf16_f32 v43, v86, v87
    v_cvt_pk_bf16_f32 v44, v88, v89
    v_cvt_pk_bf16_f32 v45, v90, v91
    v_cvt_pk_bf16_f32 v46, v92, v93
    v_cvt_pk_bf16_f32 v47, v94, v95
    v_cndmask_b32 v46, 0, v46, s[48:49]
    v_cndmask_b32 v47, 0, v47, s[48:49]
    buffer_store_dwordx4 v[40:43], v1, s[16:19], s46 offen sc0 sc1
    buffer_store_dwordx4 v[44:47], v1, s[16:19], s46 offen offset:1024 sc0 sc1
    s_cmp_lg_u64 s[60:61], 0
    s_cselect_b32 s62, 1, 0
    v_mov_b32 v7, s62
    s_lshl_b32 s37, s34, 2
    s_add_u32 s37, s37, 147456
    v_mov_b32 v6, s37
    ds_write_b32 v6, v7
    s_waitcnt lgkmcnt(0)
    s_branch Lk2_e2
Lk2_local:
    s_cmp_lg_u32 s70, 0
    s_cbranch_scc1 Lk2_e2
    v_and_b32 v3, 31, v2
    v_lshrrev_b32 v4, 5, v2
    v_lshlrev_b32 v4, 2, v4
    v_sub_u32 v8, v3, v4
    s_cmp_eq_u32 s35, 0
    s_cselect_b32 s46, 1056, 32
    v_add_u32 v9, s46, v8
    v_mov_b32 v10, 0xff800000
    s_waitcnt vmcnt(0)
    v_mfma_f32_32x32x16_bf16 v[48:63], v[132:135], v[124:127], 0
    v_mfma_f32_32x32x16_bf16 v[48:63], v[136:139], v[128:131], v[48:63]
    v_mfma_f32_32x32x16_bf16 v[64:79], v[140:143], v[124:127], 0
    v_mfma_f32_32x32x16_bf16 v[64:79], v[144:147], v[128:131], v[64:79]
    s_cmp_eq_u32 s35, 0
    s_cselect_b32 s68, 0, -1
    s_mov_b32 s69, s68
    s_mov_b32 s52, 0
    s_mov_b32 s53, 5
    s_and_b64 s[52:53], s[52:53], s[68:69]
    s_mov_b32 s54, 0
    s_mov_b32 s55, 10
    s_and_b64 s[54:55], s[54:55], s[68:69]
    s_mov_b32 s56, 1
    s_mov_b32 s57, 21
    s_and_b64 s[56:57], s[56:57], s[68:69]
    s_mov_b32 s58, 2
    s_mov_b32 s59, 42
    s_and_b64 s[58:59], s[58:59], s[68:69]
    s_mov_b32 s60, 85
    s_mov_b32 s61, 1365
    s_and_b64 s[60:61], s[60:61], s[68:69]
    s_mov_b32 s62, 170
    s_mov_b32 s63, 2730
    s_and_b64 s[62:63], s[62:63], s[68:69]
    s_mov_b32 s64, 341
    s_mov_b32 s65, 5461
    s_and_b64 s[64:65], s[64:65], s[68:69]
    s_mov_b32 s66, 682
    s_mov_b32 s67, 10922
    s_and_b64 s[66:67], s[66:67], s[68:69]
    v_cndmask_b32 v56, v10, v56, s[52:53]
    v_cndmask_b32 v57, v10, v57, s[54:55]
    v_cndmask_b32 v58, v10, v58, s[56:57]
    v_cndmask_b32 v59, v10, v59, s[58:59]
    v_cndmask_b32 v60, v10, v60, s[60:61]
    v_cndmask_b32 v61, v10, v61, s[62:63]
    v_cndmask_b32 v62, v10, v62, s[64:65]
    v_cndmask_b32 v63, v10, v63, s[66:67]
    s_mov_b32 s52, 21845
    s_mov_b32 s53, 349520
    s_mov_b32 s54, 43690
    s_mov_b32 s55, 699040
    s_mov_b32 s56, 87380
    s_mov_b32 s57, 1398080
    s_mov_b32 s58, 174760
    s_mov_b32 s59, 2796160
    s_mov_b32 s60, 5592320
    s_mov_b32 s61, 89477120
    s_mov_b32 s62, 11184640
    s_mov_b32 s63, 178954240
    s_mov_b32 s64, 22369280
    s_mov_b32 s65, 357908480
    s_mov_b32 s66, 44738560
    s_mov_b32 s67, 715816960
    v_cndmask_b32 v64, v10, v64, s[52:53]
    v_cndmask_b32 v65, v10, v65, s[54:55]
    v_cndmask_b32 v66, v10, v66, s[56:57]
    v_cndmask_b32 v67, v10, v67, s[58:59]
    v_cndmask_b32 v68, v10, v68, s[60:61]
    v_cndmask_b32 v69, v10, v69, s[62:63]
    v_cndmask_b32 v70, v10, v70, s[64:65]
    v_cndmask_b32 v71, v10, v71, s[66:67]
    s_mov_b32 s52, 1431633920
    s_mov_b32 s53, 1431306240
    s_mov_b32 s54, 2863267840
    s_mov_b32 s55, 2862612480
    s_mov_b32 s56, 1431568384
    s_mov_b32 s57, 1430257664
    s_mov_b32 s58, 2863136768
    s_mov_b32 s59, 2860515328
    s_mov_b32 s60, 1426063360
    s_mov_b32 s61, 1342177280
    s_mov_b32 s62, 2852126720
    s_mov_b32 s63, 2684354560
    s_mov_b32 s64, 1409286144
    s_mov_b32 s65, 1073741824
    s_mov_b32 s66, 2818572288
    s_mov_b32 s67, 2147483648
    v_cndmask_b32 v72, v10, v72, s[52:53]
    v_cndmask_b32 v73, v10, v73, s[54:55]
    v_cndmask_b32 v74, v10, v74, s[56:57]
    v_cndmask_b32 v75, v10, v75, s[58:59]
    v_cndmask_b32 v76, v10, v76, s[60:61]
    v_cndmask_b32 v77, v10, v77, s[62:63]
    v_cndmask_b32 v78, v10, v78, s[64:65]
    v_cndmask_b32 v79, v10, v79, s[66:67]
    v_max3_f32 v3, v56, v57, v58
    v_max3_f32 v3, v3, v59, v60
    v_max3_f32 v3, v3, v61, v62
    v_max3_f32 v3, v3, v63, v64
    v_max3_f32 v3, v3, v65, v66
    v_max3_f32 v3, v3, v67, v68
    v_max3_f32 v3, v3, v69, v70
    v_max3_f32 v3, v3, v71, v72
    v_max3_f32 v3, v3, v73, v74
    v_max3_f32 v3, v3, v75, v76
    v_max3_f32 v3, v3, v77, v78
    v_max_f32 v3, v3, v79
    v_mov_b32 v4, v3
    s_nop 1
    v_permlane32_swap_b32 v3, v4
    v_max_f32 v3, v3, v4
    v_sub_f32 v56, v56, v3
    v_sub_f32 v57, v57, v3
    v_sub_f32 v58, v58, v3
    v_sub_f32 v59, v59, v3
    v_sub_f32 v60, v60, v3
    v_sub_f32 v61, v61, v3
    v_sub_f32 v62, v62, v3
    v_sub_f32 v63, v63, v3
    v_sub_f32 v64, v64, v3
    v_sub_f32 v65, v65, v3
    v_sub_f32 v66, v66, v3
    v_sub_f32 v67, v67, v3
    v_sub_f32 v68, v68, v3
    v_sub_f32 v69, v69, v3
    v_sub_f32 v70, v70, v3
    v_sub_f32 v71, v71, v3
    v_sub_f32 v72, v72, v3
    v_sub_f32 v73, v73, v3
    v_sub_f32 v74, v74, v3
    v_sub_f32 v75, v75, v3
    v_sub_f32 v76, v76, v3
    v_sub_f32 v77, v77, v3
    v_sub_f32 v78, v78, v3
    v_sub_f32 v79, v79, v3
    v_exp_f32 v56, v56
    v_exp_f32 v57, v57
    v_exp_f32 v58, v58
    v_exp_f32 v59, v59
    v_exp_f32 v60, v60
    v_exp_f32 v61, v61
    v_exp_f32 v62, v62
    v_exp_f32 v63, v63
    v_exp_f32 v64, v64
    v_exp_f32 v65, v65
    v_exp_f32 v66, v66
    v_exp_f32 v67, v67
    v_exp_f32 v68, v68
    v_exp_f32 v69, v69
    v_exp_f32 v70, v70
    v_exp_f32 v71, v71
    v_exp_f32 v72, v72
    v_exp_f32 v73, v73
    v_exp_f32 v74, v74
    v_exp_f32 v75, v75
    v_exp_f32 v76, v76
    v_exp_f32 v77, v77
    v_exp_f32 v78, v78
    v_exp_f32 v79, v79
    s_nop 0
    v_cvt_pk_bf16_f32 v112, v56, v57
    v_cvt_pk_bf16_f32 v113, v58, v59
    v_cvt_pk_bf16_f32 v114, v60, v61
    v_cvt_pk_bf16_f32 v115, v62, v63
    v_cvt_pk_bf16_f32 v40, v64, v65
    v_cvt_pk_bf16_f32 v41, v66, v67
    v_cvt_pk_bf16_f32 v42, v68, v69
    v_cvt_pk_bf16_f32 v43, v70, v71
    v_cvt_pk_bf16_f32 v44, v72, v73
    v_cvt_pk_bf16_f32 v45, v74, v75
    v_cvt_pk_bf16_f32 v46, v76, v77
    v_cvt_pk_bf16_f32 v47, v78, v79
    s_nop 1
    v_mfma_f32_32x32x16_bf16 v[80:95], v[148:151], v[112:115], 0
    v_mfma_f32_32x32x16_bf16 v[80:95], v[152:155], v[40:43], v[80:95]
    v_mfma_f32_32x32x16_bf16 v[80:95], v[156:159], v[44:47], v[80:95]
    s_lshl_b32 s46, s35, 4
    s_add_u32 s46, s46, s32
    s_lshl_b32 s46, s46, 11
    s_add_u32 s46, s46, 12582912
    s_nop 12
    v_mov_b32 v3, v92
    v_mov_b32 v4, v92
    s_nop 1
    v_permlane32_swap_b32 v3, v4
    v_rcp_f32 v5, v4
    s_nop 0
    v_mul_f32 v80, v5, v80
    v_mul_f32 v81, v5, v81
    v_mul_f32 v82, v5, v82
    v_mul_f32 v83, v5, v83
    v_mul_f32 v84, v5, v84
    v_mul_f32 v85, v5, v85
    v_mul_f32 v86, v5, v86
    v_mul_f32 v87, v5, v87
    v_mul_f32 v88, v5, v88
    v_mul_f32 v89, v5, v89
    v_mul_f32 v90, v5, v90
    v_mul_f32 v91, v5, v91
    v_mul_f32 v92, v5, v92
    v_mul_f32 v93, v5, v93
    v_mul_f32 v94, v5, v94
    v_mul_f32 v95, v5, v95
    v_cvt_pk_bf16_f32 v40, v80, v81
    v_cvt_pk_bf16_f32 v41, v82, v83
    v_cvt_pk_bf16_f32 v42, v84, v85
    v_cvt_pk_bf16_f32 v43, v86, v87
    v_cvt_pk_bf16_f32 v44, v88, v89
    v_cvt_pk_bf16_f32 v45, v90, v91
    v_cvt_pk_bf16_f32 v46, v92, v93
    v_cvt_pk_bf16_f32 v47, v94, v95
    v_cndmask_b32 v46, 0, v46, s[48:49]
    v_cndmask_b32 v47, 0, v47, s[48:49]
    buffer_store_dwordx4 v[40:43], v1, s[16:19], s46 offen sc0 sc1
    buffer_store_dwordx4 v[44:47], v1, s[16:19], s46 offen offset:1024 sc0 sc1
Lk2_e2:
    s_barrier
    s_cmp_lg_u32 s70, 0
    s_cbranch_scc1 Lk2_end
    v_mov_b32 v6, 147456
    ds_read_b128 v[8:11], v6
    s_waitcnt lgkmcnt(0)
    v_or3_b32 v8, v8, v9, v10
    v_or_b32 v8, v8, v11
    s_nop 0
    v_readfirstlane_b32 s62, v8
    s_nop 3
    s_cmp_eq_u32 s62, 0
    s_cbranch_scc1 Lk2_end
    s_mov_b32 s70, 1
    v_mov_b32 v12, 0xff800000
    s_lshl_b32 s37, s36, 12
    v_add_u32 v13, s37, v1
    s_mov_b32 s63, 0
Lk2_fb:
    s_barrier
    s_lshl_b32 s43, s63, 13
    s_add_u32 s43, s43, s40
    s_mov_b32 m0, s41
    s_nop 0
    buffer_load_dwordx4 v1, s[16:19], s43 offen lds
    s_waitcnt vmcnt(0)
    s_barrier
    ds_read_b128 v[24:27], v13 offset:0
    ds_read_b128 v[28:31], v13 offset:1024
    s_waitcnt lgkmcnt(0)
    v_mfma_f32_32x32x16_bf16 v[48:63], v[24:27], v[16:19], 0
    v_mfma_f32_32x32x16_bf16 v[48:63], v[28:31], v[20:23], v[48:63]
    s_nop 15
    v_max3_f32 v12, v12, v48, v49
    v_max3_f32 v12, v12, v50, v51
    v_max3_f32 v12, v12, v52, v53
    v_max3_f32 v12, v12, v54, v55
    v_max3_f32 v12, v12, v56, v57
    v_max3_f32 v12, v12, v58, v59
    v_max3_f32 v12, v12, v60, v61
    v_max3_f32 v12, v12, v62, v63
    ds_read_b128 v[24:27], v13 offset:2048
    ds_read_b128 v[28:31], v13 offset:3072
    s_waitcnt lgkmcnt(0)
    v_mfma_f32_32x32x16_bf16 v[48:63], v[24:27], v[16:19], 0
    v_mfma_f32_32x32x16_bf16 v[48:63], v[28:31], v[20:23], v[48:63]
    s_nop 15
    v_max3_f32 v12, v12, v48, v49
    v_max3_f32 v12, v12, v50, v51
    v_max3_f32 v12, v12, v52, v53
    v_max3_f32 v12, v12, v54, v55
    v_max3_f32 v12, v12, v56, v57
    v_max3_f32 v12, v12, v58, v59
    v_max3_f32 v12, v12, v60, v61
    v_max3_f32 v12, v12, v62, v63
    s_add_u32 s63, s63, 1
    s_cmp_lt_u32 s63, 16
    s_cbranch_scc1 Lk2_fb
    v_mov_b32 v4, v12
    s_nop 1
    v_permlane32_swap_b32 v12, v4
    v_max_f32 v3, v12, v4
    s_lshl_b32 s37, s34, 8
    s_add_u32 s37, s37, 147712
    v_lshlrev_b32 v5, 2, v2
    v_add_u32 v6, s37, v5
    ds_write_b32 v6, v3
    s_xor_b32 s37, s34, 4
    s_lshl_b32 s37, s37, 8
    s_add_u32 s37, s37, 147712
    v_add_u32 v6, s37, v5
    s_waitcnt lgkmcnt(0)
    s_barrier
    ds_read_b32 v4, v6
    s_waitcnt lgkmcnt(0)
    v_max_f32 v3, v3, v4
    v_mov_b32 v80, 0
    v_mov_b32 v81, 0
    v_mov_b32 v82, 0
    v_mov_b32 v83, 0
    v_mov_b32 v84, 0
    v_mov_b32 v85, 0
    v_mov_b32 v86, 0
    v_mov_b32 v87, 0
    v_mov_b32 v88, 0
    v_mov_b32 v89, 0
    v_mov_b32 v90, 0
    v_mov_b32 v91, 0
    v_mov_b32 v92, 0
    v_mov_b32 v93, 0
    v_mov_b32 v94, 0
    v_mov_b32 v95, 0
    s_add_u32 s43, s40, 0
    s_add_u32 m0, s41, 0
    s_add_u32 s44, s42, 0
    buffer_load_dwordx4 v1, s[16:19], s43 offen lds
    s_add_u32 m0, s41, 65536
    s_nop 0
    buffer_load_dwordx4 v1, s[16:19], s44 offen lds
    s_add_u32 s43, s40, 8192
    s_add_u32 m0, s41, 8192
    s_add_u32 s44, s42, 8192
    buffer_load_dwordx4 v1, s[16:19], s43 offen lds
    s_add_u32 m0, s41, 73728
    s_nop 0
    buffer_load_dwordx4 v1, s[16:19], s44 offen lds
    s_add_u32 s43, s40, 16384
    s_add_u32 m0, s41, 16384
    s_add_u32 s44, s42, 16384
    buffer_load_dwordx4 v1, s[16:19], s43 offen lds
    s_add_u32 m0, s41, 81920
    s_nop 0
    buffer_load_dwordx4 v1, s[16:19], s44 offen lds
    s_add_u32 s43, s40, 24576
    s_add_u32 m0, s41, 24576
    s_add_u32 s44, s42, 24576
    buffer_load_dwordx4 v1, s[16:19], s43 offen lds
    s_add_u32 m0, s41, 90112
    s_nop 0
    buffer_load_dwordx4 v1, s[16:19], s44 offen lds
    s_add_u32 s43, s40, 32768
    s_add_u32 m0, s41, 32768
    s_add_u32 s44, s42, 32768
    buffer_load_dwordx4 v1, s[16:19], s43 offen lds
    s_add_u32 m0, s41, 98304
    s_nop 0
    buffer_load_dwordx4 v1, s[16:19], s44 offen lds
    s_add_u32 s43, s40, 40960
    s_add_u32 m0, s41, 40960
    s_add_u32 s44, s42, 40960
    buffer_load_dwordx4 v1, s[16:19], s43 offen lds
    s_add_u32 m0, s41, 106496
    s_nop 0
    buffer_load_dwordx4 v1, s[16:19], s44 offen lds
    s_waitcnt vmcnt(8)
    s_barrier
    s_branch Lk2_setci
Lk2_end:
    s_endpgm
.globl proj_kernel
.p2align 8
.type proj_kernel,@function
proj_kernel:
    s_cmp_ge_u32 s2, 224
    s_cbranch_scc1 Lk3_end
    s_load_dwordx2 s[4:5], s[0:1], 16
    s_load_dwordx2 s[6:7], s[0:1], 40
    s_load_dwordx2 s[8:9], s[0:1], 56
    s_load_dwordx2 s[12:13], s[0:1], 72
    s_mov_b32 s3, 0x24924925
    s_lshr_b32 s48, s2, 3
    s_mul_hi_u32 s32, s48, s3
    s_mul_i32 s33, s32, 7
    s_sub_u32 s33, s48, s33
    s_and_b32 s48, s2, 7
    s_lshl_b32 s48, s48, 2
    s_add_u32 s32, s32, s48
    v_lshrrev_b32 v3, 6, v0
    v_and_b32 v2, 63, v0
    v_readfirstlane_b32 s34, v3
    v_lshlrev_b32 v1, 4, v2
    s_waitcnt lgkmcnt(0)
    s_and_b32 s35, s34, 1
    s_lshr_b32 s36, s34, 1
    s_lshl_b32 s37, s32, 1
    s_add_u32 s37, s37, s35
    s_cmp_eq_u32 s36, 0
    s_cselect_b32 s4, s4, s6
    s_cselect_b32 s5, s5, s7
    s_mov_b32 s16, s4
    s_and_b32 s17, s5, 0xffff
    s_mov_b32 s18, 401408
    s_mov_b32 s19, 0x00020000
    s_mov_b32 s20, s12
    s_and_b32 s21, s13, 0xffff
    s_mov_b32 s22, 16785408
    s_mov_b32 s23, 0x00020000
    s_mov_b32 s24, s8
    s_and_b32 s25, s9, 0xffff
    s_mov_b32 s26, 1835008
    s_mov_b32 s27, 0x00020000
    v_lshrrev_b32 v3, 3, v2
    v_mul_u32_u24 v4, 896, v3
    v_lshrrev_b32 v3, 2, v2
    v_and_b32 v3, 4, v3
    v_and_b32 v5, 7, v2
    v_xor_b32 v3, v3, v5
    v_lshlrev_b32 v3, 4, v3
    v_add_u32 v4, v4, v3
    s_mul_i32 s40, s36, 57856
    s_lshl_b32 s41, s35, 10
    s_add_u32 s40, s40, s41
    s_mul_i32 s41, s35, 7168
    s_lshl_b32 s42, s33, 7
    s_add_u32 s41, s41, s42
    v_lshlrev_b32 v5, 3, v2
    s_mul_i32 s42, s36, 57856
    s_add_u32 s42, s42, 57344
    v_add_u32 v5, s42, v5
    v_mov_b32 v6, 0
    v_mov_b32 v7, 0
    ds_write_b64 v5, v[6:7]
    v_and_b32 v3, 31, v2
    v_lshlrev_b32 v5, 2, v3
    s_lshl_b32 s42, s37, 7
    s_add_u32 s42, s42, 16777216
    buffer_load_dword v14, v5, s[20:23], s42 offen
    s_lshl_b32 s46, s37, 15
    s_lshl_b32 s43, s36, 21
    s_add_u32 s46, s46, s43
    s_add_u32 s46, s46, 12582912
    s_add_u32 m0, s40, 0
    s_add_u32 s42, s41, 0
    buffer_load_dwordx4 v4, s[16:19], s42 offen lds
    s_add_u32 m0, s40, 2048
    s_add_u32 s42, s41, 14336
    buffer_load_dwordx4 v4, s[16:19], s42 offen lds
    s_add_u32 m0, s40, 4096
    s_add_u32 s42, s41, 28672
    buffer_load_dwordx4 v4, s[16:19], s42 offen lds
    s_add_u32 m0, s40, 6144
    s_add_u32 s42, s41, 43008
    buffer_load_dwordx4 v4, s[16:19], s42 offen lds
    s_add_u32 m0, s40, 8192
    s_add_u32 s42, s41, 57344
    buffer_load_dwordx4 v4, s[16:19], s42 offen lds
    s_add_u32 m0, s40, 10240
    s_add_u32 s42, s41, 71680
    buffer_load_dwordx4 v4, s[16:19], s42 offen lds
    s_add_u32 m0, s40, 12288
    s_add_u32 s42, s41, 86016
    buffer_load_dwordx4 v4, s[16:19], s42 offen lds
    s_add_u32 m0, s40, 14336
    s_add_u32 s42, s41, 100352
    buffer_load_dwordx4 v4, s[16:19], s42 offen lds
    buffer_load_dwordx4 v[16:19], v1, s[20:23], s46 offen offset:0
    buffer_load_dwordx4 v[20:23], v1, s[20:23], s46 offen offset:1024
    buffer_load_dwordx4 v[24:27], v1, s[20:23], s46 offen offset:2048
    buffer_load_dwordx4 v[28:31], v1, s[20:23], s46 offen offset:3072
    s_add_u32 s46, s46, 4096
    buffer_load_dwordx4 v[32:35], v1, s[20:23], s46 offen offset:0
    buffer_load_dwordx4 v[36:39], v1, s[20:23], s46 offen offset:1024
    buffer_load_dwordx4 v[40:43], v1, s[20:23], s46 offen offset:2048
    buffer_load_dwordx4 v[44:47], v1, s[20:23], s46 offen offset:3072
    s_add_u32 m0, s40, 16384
    s_add_u32 s42, s41, 114688
    buffer_load_dwordx4 v4, s[16:19], s42 offen lds
    s_add_u32 m0, s40, 18432
    s_add_u32 s42, s41, 129024
    buffer_load_dwordx4 v4, s[16:19], s42 offen lds
    s_add_u32 m0, s40, 20480
    s_add_u32 s42, s41, 143360
    buffer_load_dwordx4 v4, s[16:19], s42 offen lds
    s_add_u32 m0, s40, 22528
    s_add_u32 s42, s41, 157696
    buffer_load_dwordx4 v4, s[16:19], s42 offen lds
    s_add_u32 m0, s40, 24576
    s_add_u32 s42, s41, 172032
    buffer_load_dwordx4 v4, s[16:19], s42 offen lds
    s_add_u32 m0, s40, 26624
    s_add_u32 s42, s41, 186368
    buffer_load_dwordx4 v4, s[16:19], s42 offen lds
    s_add_u32 m0, s40, 28672
    s_add_u32 s42, s41, 200704
    buffer_load_dwordx4 v4, s[16:19], s42 offen lds
    s_add_u32 s46, s46, 4096
    buffer_load_dwordx4 v[48:51], v1, s[20:23], s46 offen offset:0
    buffer_load_dwordx4 v[52:55], v1, s[20:23], s46 offen offset:1024
    buffer_load_dwordx4 v[56:59], v1, s[20:23], s46 offen offset:2048
    buffer_load_dwordx4 v[60:63], v1, s[20:23], s46 offen offset:3072
    s_add_u32 s46, s46, 4096
    buffer_load_dwordx4 v[64:67], v1, s[20:23], s46 offen offset:0
    buffer_load_dwordx4 v[68:71], v1, s[20:23], s46 offen offset:1024
    buffer_load_dwordx4 v[72:75], v1, s[20:23], s46 offen offset:2048
    buffer_load_dwordx4 v[76:79], v1, s[20:23], s46 offen offset:3072
    v_lshrrev_b32 v5, 5, v2
    v_lshlrev_b32 v6, 9, v5
    v_and_b32 v5, 15, v2
    v_lshrrev_b32 v5, 2, v5
    v_lshlrev_b32 v7, 7, v5
    v_add_u32 v6, v6, v7
    v_lshrrev_b32 v5, 1, v5
    v_lshlrev_b32 v5, 6, v5
    v_add_u32 v6, v6, v5
    v_lshrrev_b32 v5, 4, v2
    v_and_b32 v5, 1, v5
    v_lshlrev_b32 v5, 5, v5
    v_add_u32 v6, v6, v5
    v_and_b32 v5, 3, v2
    v_lshlrev_b32 v5, 3, v5
    v_add_u32 v6, v6, v5
    s_mul_i32 s42, s36, 57856
    v_add_u32 v6, s42, v6
    v_xor_b32 v7, 64, v6
    s_lshl_b32 s42, s37, 5
    v_add_u32 v3, s42, v3
    v_mul_u32_u24 v8, 896, v3
    v_lshrrev_b32 v5, 5, v2
    v_lshlrev_b32 v5, 4, v5
    v_add_u32 v8, v8, v5
    s_lshl_b32 s44, s33, 7
    s_lshl_b32 s42, s36, 6
    s_add_u32 s44, s44, s42
    s_lshl_b32 s42, s34, 11
    s_add_u32 s42, s42, 115712
    v_add_u32 v9, s42, v1
    s_xor_b32 s42, s34, 2
    s_lshl_b32 s42, s42, 11
    s_add_u32 s42, s42, 115712
    v_add_u32 v10, s42, v1
    s_waitcnt lgkmcnt(0)
    s_waitcnt vmcnt(23)
    s_barrier
    ds_read_b64_tr_b16 v[176:177], v6 offset:0
    ds_read_b64_tr_b16 v[178:179], v6 offset:1024
    ds_read_b64_tr_b16 v[180:181], v7 offset:0
    ds_read_b64_tr_b16 v[182:183], v7 offset:1024
    ds_read_b64_tr_b16 v[184:185], v6 offset:2048
    ds_read_b64_tr_b16 v[186:187], v6 offset:3072
    ds_read_b64_tr_b16 v[188:189], v7 offset:2048
    ds_read_b64_tr_b16 v[190:191], v7 offset:3072
    ds_read_b64_tr_b16 v[192:193], v6 offset:3584
    ds_read_b64_tr_b16 v[194:195], v6 offset:4608
    ds_read_b64_tr_b16 v[196:197], v7 offset:3584
    ds_read_b64_tr_b16 v[198:199], v7 offset:4608
    ds_read_b64_tr_b16 v[200:201], v6 offset:5632
    ds_read_b64_tr_b16 v[202:203], v6 offset:6656
    ds_read_b64_tr_b16 v[204:205], v7 offset:5632
    ds_read_b64_tr_b16 v[206:207], v7 offset:6656
    s_waitcnt vmcnt(22) lgkmcnt(12)
    v_mfma_f32_32x32x16_bf16 v[144:159], v[176:179], v[16:19], 0
    v_mfma_f32_32x32x16_bf16 v[160:175], v[180:183], v[16:19], 0
    s_add_u32 m0, s40, 30720
    s_add_u32 s42, s41, 215040
    buffer_load_dwordx4 v4, s[16:19], s42 offen lds
    s_add_u32 m0, s40, 32768
    s_add_u32 s42, s41, 229376
    buffer_load_dwordx4 v4, s[16:19], s42 offen lds
    ds_read_b64_tr_b16 v[176:177], v6 offset:7168
    ds_read_b64_tr_b16 v[178:179], v6 offset:8192
    ds_read_b64_tr_b16 v[180:181], v7 offset:7168
    ds_read_b64_tr_b16 v[182:183], v7 offset:8192
    s_waitcnt vmcnt(23) lgkmcnt(12)
    v_mfma_f32_32x32x16_bf16 v[144:159], v[184:187], v[20:23], v[144:159]
    v_mfma_f32_32x32x16_bf16 v[160:175], v[188:191], v[20:23], v[160:175]
    s_add_u32 m0, s40, 34816
    s_add_u32 s42, s41, 243712
    buffer_load_dwordx4 v4, s[16:19], s42 offen lds
    s_add_u32 m0, s40, 36864
    s_add_u32 s42, s41, 258048
    buffer_load_dwordx4 v4, s[16:19], s42 offen lds
    ds_read_b64_tr_b16 v[184:185], v6 offset:9216
    ds_read_b64_tr_b16 v[186:187], v6 offset:10240
    ds_read_b64_tr_b16 v[188:189], v7 offset:9216
    ds_read_b64_tr_b16 v[190:191], v7 offset:10240
    s_waitcnt vmcnt(24) lgkmcnt(12)
    v_mfma_f32_32x32x16_bf16 v[144:159], v[192:195], v[24:27], v[144:159]
    v_mfma_f32_32x32x16_bf16 v[160:175], v[196:199], v[24:27], v[160:175]
    s_add_u32 m0, s40, 38912
    s_add_u32 s42, s41, 272384
    buffer_load_dwordx4 v4, s[16:19], s42 offen lds
    s_add_u32 m0, s40, 40960
    s_add_u32 s42, s41, 286720
    buffer_load_dwordx4 v4, s[16:19], s42 offen lds
    ds_read_b64_tr_b16 v[192:193], v6 offset:10752
    ds_read_b64_tr_b16 v[194:195], v6 offset:11776
    ds_read_b64_tr_b16 v[196:197], v7 offset:10752
    ds_read_b64_tr_b16 v[198:199], v7 offset:11776
    s_waitcnt vmcnt(25) lgkmcnt(12)
    v_mfma_f32_32x32x16_bf16 v[144:159], v[200:203], v[28:31], v[144:159]
    v_mfma_f32_32x32x16_bf16 v[160:175], v[204:207], v[28:31], v[160:175]
    s_add_u32 m0, s40, 43008
    s_add_u32 s42, s41, 301056
    buffer_load_dwordx4 v4, s[16:19], s42 offen lds
    s_add_u32 s46, s46, 4096
    buffer_load_dwordx4 v[80:83], v1, s[20:23], s46 offen offset:0
    ds_read_b64_tr_b16 v[200:201], v6 offset:12800
    ds_read_b64_tr_b16 v[202:203], v6 offset:13824
    ds_read_b64_tr_b16 v[204:205], v7 offset:12800
    ds_read_b64_tr_b16 v[206:207], v7 offset:13824
    s_waitcnt vmcnt(26) lgkmcnt(12)
    v_mfma_f32_32x32x16_bf16 v[144:159], v[176:179], v[32:35], v[144:159]
    v_mfma_f32_32x32x16_bf16 v[160:175], v[180:183], v[32:35], v[160:175]
    buffer_load_dwordx4 v[84:87], v1, s[20:23], s46 offen offset:1024
    buffer_load_dwordx4 v[88:91], v1, s[20:23], s46 offen offset:2048
    s_waitcnt vmcnt(18)
    s_barrier
    ds_read_b64_tr_b16 v[176:177], v6 offset:14336
    ds_read_b64_tr_b16 v[178:179], v6 offset:15360
    ds_read_b64_tr_b16 v[180:181], v7 offset:14336
    ds_read_b64_tr_b16 v[182:183], v7 offset:15360
    s_waitcnt lgkmcnt(12)
    v_mfma_f32_32x32x16_bf16 v[144:159], v[184:187], v[36:39], v[144:159]
    v_mfma_f32_32x32x16_bf16 v[160:175], v[188:191], v[36:39], v[160:175]
    buffer_load_dwordx4 v[92:95], v1, s[20:23], s46 offen offset:3072
    s_add_u32 s46, s46, 4096
    buffer_load_dwordx4 v[96:99], v1, s[20:23], s46 offen offset:0
    ds_read_b64_tr_b16 v[184:185], v6 offset:16384
    ds_read_b64_tr_b16 v[186:187], v6 offset:17408
    ds_read_b64_tr_b16 v[188:189], v7 offset:16384
    ds_read_b64_tr_b16 v[190:191], v7 offset:17408
    s_waitcnt lgkmcnt(12)
    v_mfma_f32_32x32x16_bf16 v[144:159], v[192:195], v[40:43], v[144:159]
    v_mfma_f32_32x32x16_bf16 v[160:175], v[196:199], v[40:43], v[160:175]
    buffer_load_dwordx4 v[100:103], v1, s[20:23], s46 offen offset:1024
    buffer_load_dwordx4 v[104:107], v1, s[20:23], s46 offen offset:2048
    ds_read_b64_tr_b16 v[192:193], v6 offset:17920
    ds_read_b64_tr_b16 v[194:195], v6 offset:18944
    ds_read_b64_tr_b16 v[196:197], v7 offset:17920
    ds_read_b64_tr_b16 v[198:199], v7 offset:18944
    s_waitcnt lgkmcnt(12)
    v_mfma_f32_32x32x16_bf16 v[144:159], v[200:203], v[44:47], v[144:159]
    v_mfma_f32_32x32x16_bf16 v[160:175], v[204:207], v[44:47], v[160:175]
    buffer_load_dwordx4 v[108:111], v1, s[20:23], s46 offen offset:3072
    ds_read_b64_tr_b16 v[200:201], v6 offset:19968
    ds_read_b64_tr_b16 v[202:203], v6 offset:20992
    ds_read_b64_tr_b16 v[204:205], v7 offset:19968
    ds_read_b64_tr_b16 v[206:207], v7 offset:20992
    s_waitcnt vmcnt(22) lgkmcnt(12)
    v_mfma_f32_32x32x16_bf16 v[144:159], v[176:179], v[48:51], v[144:159]
    v_mfma_f32_32x32x16_bf16 v[160:175], v[180:183], v[48:51], v[160:175]
    s_add_u32 m0, s40, 45056
    s_add_u32 s42, s41, 315392
    buffer_load_dwordx4 v4, s[16:19], s42 offen lds
    s_add_u32 m0, s40, 47104
    s_add_u32 s42, s41, 329728
    buffer_load_dwordx4 v4, s[16:19], s42 offen lds
    ds_read_b64_tr_b16 v[176:177], v6 offset:21504
    ds_read_b64_tr_b16 v[178:179], v6 offset:22528
    ds_read_b64_tr_b16 v[180:181], v7 offset:21504
    ds_read_b64_tr_b16 v[182:183], v7 offset:22528
    s_waitcnt vmcnt(23) lgkmcnt(12)
    v_mfma_f32_32x32x16_bf16 v[144:159], v[184:187], v[52:55], v[144:159]
    v_mfma_f32_32x32x16_bf16 v[160:175], v[188:191], v[52:55], v[160:175]
    s_add_u32 m0, s40, 49152
    s_add_u32 s42, s41, 344064
    buffer_load_dwordx4 v4, s[16:19], s42 offen lds
    s_add_u32 m0, s40, 51200
    s_add_u32 s42, s41, 358400
    buffer_load_dwordx4 v4, s[16:19], s42 offen lds
    ds_read_b64_tr_b16 v[184:185], v6 offset:23552
    ds_read_b64_tr_b16 v[186:187], v6 offset:24576
    ds_read_b64_tr_b16 v[188:189], v7 offset:23552
    ds_read_b64_tr_b16 v[190:191], v7 offset:24576
    s_waitcnt vmcnt(24) lgkmcnt(12)
    v_mfma_f32_32x32x16_bf16 v[144:159], v[192:195], v[56:59], v[144:159]
    v_mfma_f32_32x32x16_bf16 v[160:175], v[196:199], v[56:59], v[160:175]
    s_add_u32 m0, s40, 53248
    s_add_u32 s42, s41, 372736
    buffer_load_dwordx4 v4, s[16:19], s42 offen lds
    s_add_u32 m0, s40, 55296
    s_add_u32 s42, s41, 387072
    buffer_load_dwordx4 v4, s[16:19], s42 offen lds
    ds_read_b64_tr_b16 v[192:193], v6 offset:25088
    ds_read_b64_tr_b16 v[194:195], v6 offset:26112
    ds_read_b64_tr_b16 v[196:197], v7 offset:25088
    ds_read_b64_tr_b16 v[198:199], v7 offset:26112
    s_waitcnt vmcnt(25) lgkmcnt(12)
    v_mfma_f32_32x32x16_bf16 v[144:159], v[200:203], v[60:63], v[144:159]
    v_mfma_f32_32x32x16_bf16 v[160:175], v[204:207], v[60:63], v[160:175]
    s_add_u32 s46, s46, 4096
    buffer_load_dwordx4 v[112:115], v1, s[20:23], s46 offen offset:0
    buffer_load_dwordx4 v[116:119], v1, s[20:23], s46 offen offset:1024
    ds_read_b64_tr_b16 v[200:201], v6 offset:27136
    ds_read_b64_tr_b16 v[202:203], v6 offset:28160
    ds_read_b64_tr_b16 v[204:205], v7 offset:27136
    ds_read_b64_tr_b16 v[206:207], v7 offset:28160
    s_waitcnt vmcnt(26) lgkmcnt(12)
    v_mfma_f32_32x32x16_bf16 v[144:159], v[176:179], v[64:67], v[144:159]
    v_mfma_f32_32x32x16_bf16 v[160:175], v[180:183], v[64:67], v[160:175]
    buffer_load_dwordx4 v[120:123], v1, s[20:23], s46 offen offset:2048
    buffer_load_dwordx4 v[124:127], v1, s[20:23], s46 offen offset:3072
    s_waitcnt vmcnt(18)
    s_barrier
    ds_read_b64_tr_b16 v[176:177], v6 offset:28672
    ds_read_b64_tr_b16 v[178:179], v6 offset:29696
    ds_read_b64_tr_b16 v[180:181], v7 offset:28672
    ds_read_b64_tr_b16 v[182:183], v7 offset:29696
    s_waitcnt lgkmcnt(12)
    v_mfma_f32_32x32x16_bf16 v[144:159], v[184:187], v[68:71], v[144:159]
    v_mfma_f32_32x32x16_bf16 v[160:175], v[188:191], v[68:71], v[160:175]
    s_add_u32 s46, s46, 4096
    buffer_load_dwordx4 v[128:131], v1, s[20:23], s46 offen offset:0
    buffer_load_dwordx4 v[132:135], v1, s[20:23], s46 offen offset:1024
    ds_read_b64_tr_b16 v[184:185], v6 offset:30720
    ds_read_b64_tr_b16 v[186:187], v6 offset:31744
    ds_read_b64_tr_b16 v[188:189], v7 offset:30720
    ds_read_b64_tr_b16 v[190:191], v7 offset:31744
    s_waitcnt lgkmcnt(12)
    v_mfma_f32_32x32x16_bf16 v[144:159], v[192:195], v[72:75], v[144:159]
    v_mfma_f32_32x32x16_bf16 v[160:175], v[196:199], v[72:75], v[160:175]
    buffer_load_dwordx4 v[136:139], v1, s[20:23], s46 offen offset:2048
    buffer_load_dwordx4 v[140:143], v1, s[20:23], s46 offen offset:3072
    ds_read_b64_tr_b16 v[192:193], v6 offset:32256
    ds_read_b64_tr_b16 v[194:195], v6 offset:33280
    ds_read_b64_tr_b16 v[196:197], v7 offset:32256
    ds_read_b64_tr_b16 v[198:199], v7 offset:33280
    s_waitcnt lgkmcnt(12)
    v_mfma_f32_32x32x16_bf16 v[144:159], v[200:203], v[76:79], v[144:159]
    v_mfma_f32_32x32x16_bf16 v[160:175], v[204:207], v[76:79], v[160:175]
    ds_read_b64_tr_b16 v[200:201], v6 offset:34304
    ds_read_b64_tr_b16 v[202:203], v6 offset:35328
    ds_read_b64_tr_b16 v[204:205], v7 offset:34304
    ds_read_b64_tr_b16 v[206:207], v7 offset:35328
    s_waitcnt vmcnt(21) lgkmcnt(12)
    v_mfma_f32_32x32x16_bf16 v[144:159], v[176:179], v[80:83], v[144:159]
    v_mfma_f32_32x32x16_bf16 v[160:175], v[180:183], v[80:83], v[160:175]
    ds_read_b64_tr_b16 v[176:177], v6 offset:35840
    ds_read_b64_tr_b16 v[178:179], v6 offset:36864
    ds_read_b64_tr_b16 v[180:181], v7 offset:35840
    ds_read_b64_tr_b16 v[182:183], v7 offset:36864
    s_waitcnt vmcnt(20) lgkmcnt(12)
    v_mfma_f32_32x32x16_bf16 v[144:159], v[184:187], v[84:87], v[144:159]
    v_mfma_f32_32x32x16_bf16 v[160:175], v[188:191], v[84:87], v[160:175]
    ds_read_b64_tr_b16 v[184:185], v6 offset:37888
    ds_read_b64_tr_b16 v[186:187], v6 offset:38912
    ds_read_b64_tr_b16 v[188:189], v7 offset:37888
    ds_read_b64_tr_b16 v[190:191], v7 offset:38912
    s_waitcnt vmcnt(19) lgkmcnt(12)
    v_mfma_f32_32x32x16_bf16 v[144:159], v[192:195], v[88:91], v[144:159]
    v_mfma_f32_32x32x16_bf16 v[160:175], v[196:199], v[88:91], v[160:175]
    ds_read_b64_tr_b16 v[192:193], v6 offset:39424
    ds_read_b64_tr_b16 v[194:195], v6 offset:40448
    ds_read_b64_tr_b16 v[196:197], v7 offset:39424
    ds_read_b64_tr_b16 v[198:199], v7 offset:40448
    s_waitcnt vmcnt(18) lgkmcnt(12)
    v_mfma_f32_32x32x16_bf16 v[144:159], v[200:203], v[92:95], v[144:159]
    v_mfma_f32_32x32x16_bf16 v[160:175], v[204:207], v[92:95], v[160:175]
    ds_read_b64_tr_b16 v[200:201], v6 offset:41472
    ds_read_b64_tr_b16 v[202:203], v6 offset:42496
    ds_read_b64_tr_b16 v[204:205], v7 offset:41472
    ds_read_b64_tr_b16 v[206:207], v7 offset:42496
    s_waitcnt vmcnt(17) lgkmcnt(12)
    v_mfma_f32_32x32x16_bf16 v[144:159], v[176:179], v[96:99], v[144:159]
    v_mfma_f32_32x32x16_bf16 v[160:175], v[180:183], v[96:99], v[160:175]
    s_waitcnt vmcnt(8)
    s_barrier
    ds_read_b64_tr_b16 v[176:177], v6 offset:43008
    ds_read_b64_tr_b16 v[178:179], v6 offset:44032
    ds_read_b64_tr_b16 v[180:181], v7 offset:43008
    ds_read_b64_tr_b16 v[182:183], v7 offset:44032
    s_waitcnt lgkmcnt(12)
    v_mfma_f32_32x32x16_bf16 v[144:159], v[184:187], v[100:103], v[144:159]
    v_mfma_f32_32x32x16_bf16 v[160:175], v[188:191], v[100:103], v[160:175]
    ds_read_b64_tr_b16 v[184:185], v6 offset:45056
    ds_read_b64_tr_b16 v[186:187], v6 offset:46080
    ds_read_b64_tr_b16 v[188:189], v7 offset:45056
    ds_read_b64_tr_b16 v[190:191], v7 offset:46080
    s_waitcnt lgkmcnt(12)
    v_mfma_f32_32x32x16_bf16 v[144:159], v[192:195], v[104:107], v[144:159]
    v_mfma_f32_32x32x16_bf16 v[160:175], v[196:199], v[104:107], v[160:175]
    ds_read_b64_tr_b16 v[192:193], v6 offset:46592
    ds_read_b64_tr_b16 v[194:195], v6 offset:47616
    ds_read_b64_tr_b16 v[196:197], v7 offset:46592
    ds_read_b64_tr_b16 v[198:199], v7 offset:47616
    s_waitcnt lgkmcnt(12)
    v_mfma_f32_32x32x16_bf16 v[144:159], v[200:203], v[108:111], v[144:159]
    v_mfma_f32_32x32x16_bf16 v[160:175], v[204:207], v[108:111], v[160:175]
    ds_read_b64_tr_b16 v[200:201], v6 offset:48640
    ds_read_b64_tr_b16 v[202:203], v6 offset:49664
    ds_read_b64_tr_b16 v[204:205], v7 offset:48640
    ds_read_b64_tr_b16 v[206:207], v7 offset:49664
    s_waitcnt vmcnt(7) lgkmcnt(12)
    v_mfma_f32_32x32x16_bf16 v[144:159], v[176:179], v[112:115], v[144:159]
    v_mfma_f32_32x32x16_bf16 v[160:175], v[180:183], v[112:115], v[160:175]
    ds_read_b64_tr_b16 v[176:177], v6 offset:50176
    ds_read_b64_tr_b16 v[178:179], v6 offset:51200
    ds_read_b64_tr_b16 v[180:181], v7 offset:50176
    ds_read_b64_tr_b16 v[182:183], v7 offset:51200
    s_waitcnt vmcnt(6) lgkmcnt(12)
    v_mfma_f32_32x32x16_bf16 v[144:159], v[184:187], v[116:119], v[144:159]
    v_mfma_f32_32x32x16_bf16 v[160:175], v[188:191], v[116:119], v[160:175]
    ds_read_b64_tr_b16 v[184:185], v6 offset:52224
    ds_read_b64_tr_b16 v[186:187], v6 offset:53248
    ds_read_b64_tr_b16 v[188:189], v7 offset:52224
    ds_read_b64_tr_b16 v[190:191], v7 offset:53248
    s_waitcnt vmcnt(5) lgkmcnt(12)
    v_mfma_f32_32x32x16_bf16 v[144:159], v[192:195], v[120:123], v[144:159]
    v_mfma_f32_32x32x16_bf16 v[160:175], v[196:199], v[120:123], v[160:175]
    ds_read_b64_tr_b16 v[192:193], v6 offset:53760
    ds_read_b64_tr_b16 v[194:195], v6 offset:54784
    ds_read_b64_tr_b16 v[196:197], v7 offset:53760
    ds_read_b64_tr_b16 v[198:199], v7 offset:54784
    s_waitcnt vmcnt(4) lgkmcnt(12)
    v_mfma_f32_32x32x16_bf16 v[144:159], v[200:203], v[124:127], v[144:159]
    v_mfma_f32_32x32x16_bf16 v[160:175], v[204:207], v[124:127], v[160:175]
    ds_read_b64_tr_b16 v[200:201], v6 offset:55808
    ds_read_b64_tr_b16 v[202:203], v6 offset:56832
    ds_read_b64_tr_b16 v[204:205], v7 offset:55808
    ds_read_b64_tr_b16 v[206:207], v7 offset:56832
    s_waitcnt vmcnt(3) lgkmcnt(12)
    v_mfma_f32_32x32x16_bf16 v[144:159], v[176:179], v[128:131], v[144:159]
    v_mfma_f32_32x32x16_bf16 v[160:175], v[180:183], v[128:131], v[160:175]
    s_waitcnt vmcnt(2) lgkmcnt(8)
    v_mfma_f32_32x32x16_bf16 v[144:159], v[184:187], v[132:135], v[144:159]
    v_mfma_f32_32x32x16_bf16 v[160:175], v[188:191], v[132:135], v[160:175]
    s_waitcnt vmcnt(1) lgkmcnt(4)
    v_mfma_f32_32x32x16_bf16 v[144:159], v[192:195], v[136:139], v[144:159]
    v_mfma_f32_32x32x16_bf16 v[160:175], v[196:199], v[136:139], v[160:175]
    s_waitcnt vmcnt(0) lgkmcnt(0)
    v_mfma_f32_32x32x16_bf16 v[144:159], v[200:203], v[140:143], v[144:159]
    v_mfma_f32_32x32x16_bf16 v[160:175], v[204:207], v[140:143], v[160:175]
    v_sub_f32 v15, 1.0, v14
    v_cvt_pk_bf16_f32 v15, v15, v15
    v_lshlrev_b32 v15, 16, v15
    s_mov_b32 s45, 0xffff0000
    s_cmp_eq_u32 s36, 0
    s_cbranch_scc1 Lk3_t0
    v_mov_b32 v13, v14
    v_mov_b32 v14, v15
    v_mov_b32 v15, v13
Lk3_t0:
    s_nop 10
    v_cvt_pk_bf16_f32 v208, v144, v145
    v_cvt_pk_bf16_f32 v209, v146, v147
    v_cvt_pk_bf16_f32 v210, v148, v149
    v_cvt_pk_bf16_f32 v211, v150, v151
    v_cvt_pk_bf16_f32 v212, v152, v153
    v_cvt_pk_bf16_f32 v213, v154, v155
    v_cvt_pk_bf16_f32 v214, v156, v157
    v_cvt_pk_bf16_f32 v215, v158, v159
    v_cvt_pk_bf16_f32 v216, v160, v161
    v_cvt_pk_bf16_f32 v217, v162, v163
    v_cvt_pk_bf16_f32 v218, v164, v165
    v_cvt_pk_bf16_f32 v219, v166, v167
    v_cvt_pk_bf16_f32 v220, v168, v169
    v_cvt_pk_bf16_f32 v221, v170, v171
    v_cvt_pk_bf16_f32 v222, v172, v173
    v_cvt_pk_bf16_f32 v223, v174, v175
    s_cmp_eq_u32 s36, 0
    s_cbranch_scc1 Lk3_t1
    v_swap_b32 v208, v216
    v_swap_b32 v209, v217
    v_swap_b32 v210, v218
    v_swap_b32 v211, v219
    v_swap_b32 v212, v220
    v_swap_b32 v213, v221
    v_swap_b32 v214, v222
    v_swap_b32 v215, v223
Lk3_t1:
    ds_write_b128 v9, v[216:219]
    ds_write_b128 v9, v[220:223] offset:1024
    s_waitcnt lgkmcnt(0)
    s_barrier
    ds_read_b128 v[216:219], v10
    ds_read_b128 v[220:223], v10 offset:1024
    v_lshlrev_b32 v144, 16, v208
    v_and_b32 v145, s45, v208
    v_lshlrev_b32 v146, 16, v209
    v_and_b32 v147, s45, v209
    v_lshlrev_b32 v148, 16, v210
    v_and_b32 v149, s45, v210
    v_lshlrev_b32 v150, 16, v211
    v_and_b32 v151, s45, v211
    v_lshlrev_b32 v152, 16, v212
    v_and_b32 v153, s45, v212
    v_lshlrev_b32 v154, 16, v213
    v_and_b32 v155, s45, v213
    v_lshlrev_b32 v156, 16, v214
    v_and_b32 v157, s45, v214
    v_lshlrev_b32 v158, 16, v215
    v_and_b32 v159, s45, v215
    v_mul_f32 v144, v14, v144
    v_mul_f32 v145, v14, v145
    v_mul_f32 v146, v14, v146
    v_mul_f32 v147, v14, v147
    v_mul_f32 v148, v14, v148
    v_mul_f32 v149, v14, v149
    v_mul_f32 v150, v14, v150
    v_mul_f32 v151, v14, v151
    v_mul_f32 v152, v14, v152
    v_mul_f32 v153, v14, v153
    v_mul_f32 v154, v14, v154
    v_mul_f32 v155, v14, v155
    v_mul_f32 v156, v14, v156
    v_mul_f32 v157, v14, v157
    v_mul_f32 v158, v14, v158
    v_mul_f32 v159, v14, v159
    v_cvt_pk_bf16_f32 v208, v144, v145
    v_cvt_pk_bf16_f32 v209, v146, v147
    v_cvt_pk_bf16_f32 v210, v148, v149
    v_cvt_pk_bf16_f32 v211, v150, v151
    v_cvt_pk_bf16_f32 v212, v152, v153
    v_cvt_pk_bf16_f32 v213, v154, v155
    v_cvt_pk_bf16_f32 v214, v156, v157
    v_cvt_pk_bf16_f32 v215, v158, v159
    v_lshlrev_b32 v144, 16, v208
    v_and_b32 v145, s45, v208
    v_lshlrev_b32 v146, 16, v209
    v_and_b32 v147, s45, v209
    v_lshlrev_b32 v148, 16, v210
    v_and_b32 v149, s45, v210
    v_lshlrev_b32 v150, 16, v211
    v_and_b32 v151, s45, v211
    v_lshlrev_b32 v152, 16, v212
    v_and_b32 v153, s45, v212
    v_lshlrev_b32 v154, 16, v213
    v_and_b32 v155, s45, v213
    v_lshlrev_b32 v156, 16, v214
    v_and_b32 v157, s45, v214
    v_lshlrev_b32 v158, 16, v215
    v_and_b32 v159, s45, v215
    s_waitcnt lgkmcnt(0)
    v_lshlrev_b32 v160, 16, v216
    v_and_b32 v161, s45, v216
    v_lshlrev_b32 v162, 16, v217
    v_and_b32 v163, s45, v217
    v_lshlrev_b32 v164, 16, v218
    v_and_b32 v165, s45, v218
    v_lshlrev_b32 v166, 16, v219
    v_and_b32 v167, s45, v219
    v_lshlrev_b32 v168, 16, v220
    v_and_b32 v169, s45, v220
    v_lshlrev_b32 v170, 16, v221
    v_and_b32 v171, s45, v221
    v_lshlrev_b32 v172, 16, v222
    v_and_b32 v173, s45, v222
    v_lshlrev_b32 v174, 16, v223
    v_and_b32 v175, s45, v223
    v_mul_f32 v160, v15, v160
    v_mul_f32 v161, v15, v161
    v_mul_f32 v162, v15, v162
    v_mul_f32 v163, v15, v163
    v_mul_f32 v164, v15, v164
    v_mul_f32 v165, v15, v165
    v_mul_f32 v166, v15, v166
    v_mul_f32 v167, v15, v167
    v_mul_f32 v168, v15, v168
    v_mul_f32 v169, v15, v169
    v_mul_f32 v170, v15, v170
    v_mul_f32 v171, v15, v171
    v_mul_f32 v172, v15, v172
    v_mul_f32 v173, v15, v173
    v_mul_f32 v174, v15, v174
    v_mul_f32 v175, v15, v175
    v_cvt_pk_bf16_f32 v216, v160, v161
    v_cvt_pk_bf16_f32 v217, v162, v163
    v_cvt_pk_bf16_f32 v218, v164, v165
    v_cvt_pk_bf16_f32 v219, v166, v167
    v_cvt_pk_bf16_f32 v220, v168, v169
    v_cvt_pk_bf16_f32 v221, v170, v171
    v_cvt_pk_bf16_f32 v222, v172, v173
    v_cvt_pk_bf16_f32 v223, v174, v175
    v_lshlrev_b32 v160, 16, v216
    v_and_b32 v161, s45, v216
    v_lshlrev_b32 v162, 16, v217
    v_and_b32 v163, s45, v217
    v_lshlrev_b32 v164, 16, v218
    v_and_b32 v165, s45, v218
    v_lshlrev_b32 v166, 16, v219
    v_and_b32 v167, s45, v219
    v_lshlrev_b32 v168, 16, v220
    v_and_b32 v169, s45, v220
    v_lshlrev_b32 v170, 16, v221
    v_and_b32 v171, s45, v221
    v_lshlrev_b32 v172, 16, v222
    v_and_b32 v173, s45, v222
    v_lshlrev_b32 v174, 16, v223
    v_and_b32 v175, s45, v223
    v_add_f32 v144, v144, v160
    v_add_f32 v145, v145, v161
    v_add_f32 v146, v146, v162
    v_add_f32 v147, v147, v163
    v_add_f32 v148, v148, v164
    v_add_f32 v149, v149, v165
    v_add_f32 v150, v150, v166
    v_add_f32 v151, v151, v167
    v_add_f32 v152, v152, v168
    v_add_f32 v153, v153, v169
    v_add_f32 v154, v154, v170
    v_add_f32 v155, v155, v171
    v_add_f32 v156, v156, v172
    v_add_f32 v157, v157, v173
    v_add_f32 v158, v158, v174
    v_add_f32 v159, v159, v175
    v_cvt_pk_bf16_f32 v208, v144, v145
    v_cvt_pk_bf16_f32 v209, v146, v147
    v_cvt_pk_bf16_f32 v210, v148, v149
    v_cvt_pk_bf16_f32 v211, v150, v151
    v_cvt_pk_bf16_f32 v212, v152, v153
    v_cvt_pk_bf16_f32 v213, v154, v155
    v_cvt_pk_bf16_f32 v214, v156, v157
    v_cvt_pk_bf16_f32 v215, v158, v159
    s_nop 1
    v_permlane32_swap_b32 v208, v210
    v_permlane32_swap_b32 v209, v211
    v_permlane32_swap_b32 v212, v214
    v_permlane32_swap_b32 v213, v215
    buffer_store_dwordx4 v[208:211], v8, s[24:27], s44 offen offset:0
    buffer_store_dwordx4 v[212:215], v8, s[24:27], s44 offen offset:32
Lk3_end:
    s_endpgm
.section .rodata,"a"
.p2align 6
.p2align 6
.amdhsa_kernel qkv_kernel
  .amdhsa_next_free_vgpr 144
  .amdhsa_next_free_sgpr 102
  .amdhsa_accum_offset 144
  .amdhsa_group_segment_fixed_size 0
  .amdhsa_kernarg_size 80
  .amdhsa_user_sgpr_count 2
  .amdhsa_user_sgpr_kernarg_segment_ptr 1
  .amdhsa_system_sgpr_workgroup_id_x 1
.end_amdhsa_kernel
.p2align 6
.amdhsa_kernel attn_kernel
  .amdhsa_next_free_vgpr 176
  .amdhsa_next_free_sgpr 102
  .amdhsa_accum_offset 176
  .amdhsa_group_segment_fixed_size 0
  .amdhsa_kernarg_size 80
  .amdhsa_user_sgpr_count 2
  .amdhsa_user_sgpr_kernarg_segment_ptr 1
  .amdhsa_system_sgpr_workgroup_id_x 1
.end_amdhsa_kernel
.p2align 6
.amdhsa_kernel proj_kernel
  .amdhsa_next_free_vgpr 240
  .amdhsa_next_free_sgpr 102
  .amdhsa_accum_offset 240
  .amdhsa_group_segment_fixed_size 0
  .amdhsa_kernarg_size 80
  .amdhsa_user_sgpr_count 2
  .amdhsa_user_sgpr_kernarg_segment_ptr 1
  .amdhsa_system_sgpr_workgroup_id_x 1
.end_amdhsa_kernel
```
